```python
import torch

def _softmax(x, axis=-1):
    return torch.softmax(x, dim=axis)
def _gelu(x):
    return torch.nn.functional.gelu(x, approximate="tanh")
def _silu(x):
    return torch.nn.functional.silu(x)
def _sigmoid(x):
    return torch.sigmoid(x)
def _layernorm(x, axis=-1, eps=1e-5):
    m = x.mean(dim=axis, keepdim=True)
    v = x.var(dim=axis, keepdim=True, unbiased=False)
    return (x - m) / torch.sqrt(v + eps)
def _scatter_add(tgt, idx, src, axis=0):
    return tgt.clone().index_add_(axis, idx, src)
def _segment_sum(src, seg, n):
    out = torch.zeros((n,) + src.shape[1:], dtype=src.dtype)
    return out.index_add_(0, seg, src)
def _pad(x, pw):
    flat = tuple(v for pair in reversed(pw) for v in pair)
    return torch.nn.functional.pad(x, flat)

kernel_name = 'sequential_preLN__ssm_conv_s4d__dense_activation_silu__prompt'

def setup_inputs():

    _w = (lambda a: (lambda t: t.to(torch.bfloat16) if t.is_floating_point() else t)(torch.as_tensor(a)))
    def _A_setup():
        Bsz, L, D, N = 1, 2048, 448, 256
        return {
            "u": _w((lambda *s: torch.randn(*s, dtype=torch.bfloat16) * 0.05)(Bsz, L, D)),
            "log_A_real": _w((lambda *s: torch.randn(*s, dtype=torch.bfloat16) * 6.4)(D, N) * 0.5),
            "A_imag": _w((lambda *s: torch.randn(*s, dtype=torch.bfloat16) * 0.05)(D, N) * 3.14),
            "C_real": _w((lambda *s: torch.randn(*s, dtype=torch.bfloat16) * 0.05)(D, N) / N ** 0.5),
            "C_imag": _w((lambda *s: torch.randn(*s, dtype=torch.bfloat16) * 0.05)(D, N) / N ** 0.5),
            "log_dt": _w((lambda *s: torch.randn(*s, dtype=torch.bfloat16) * 0.05)(D) * 0.5 - 4.0),
            "D_skip": _w((lambda *s: torch.randn(*s, dtype=torch.bfloat16) * 0.05)(D)),
        }
    _A_in = _A_setup()

    def _B_setup():
        B, S, D, F = 1, 2048, 448, 1792
        return {
            "x": _w((lambda *s: torch.randn(*s, dtype=torch.bfloat16) * 0.05)(B, S, D)),
            "w1": _w((lambda *s: torch.randn(*s, dtype=torch.bfloat16) * 0.8)(D, F) * (D ** -0.5)),
            "w2": _w((lambda *s: torch.randn(*s, dtype=torch.bfloat16) * 0.2)(F, D) * (F ** -0.5)),
        }
    _B_in = _B_setup()

    return {
        "A_u": _A_in["u"],
        "A_log_A_real": _A_in["log_A_real"],
        "A_A_imag": _A_in["A_imag"],
        "A_C_real": _A_in["C_real"],
        "A_C_imag": _A_in["C_imag"],
        "A_log_dt": _A_in["log_dt"],
        "A_D_skip": _A_in["D_skip"],
        "B_x": _B_in["x"],
        "B_w1": _B_in["w1"],
        "B_w2": _B_in["w2"],
    }

def reference(A_u, A_log_A_real, A_A_imag, A_C_real, A_C_imag, A_log_dt, A_D_skip, B_x, B_w1, B_w2):
    def _A_ref(u, log_A_real, A_imag, C_real, C_imag, log_dt, D_skip):
        L = u.shape[1]
        dt = torch.exp(log_dt)
        A = -torch.exp(log_A_real) + 1j * A_imag
        C = (C_real + 1j * C_imag) * dt[:, None]
        pos = (lambda x, dt: x.to(dt))(torch.arange(L), log_dt.dtype)
        P = torch.exp((A * dt[:, None])[:, :, None] * pos[None, None, :])
        K = 2.0 * torch.einsum("dn,dnl->dl", C, P).real
        L2 = 2 * L
        u_t = (lambda x, *d: x.permute(*d))(u, 0, 2, 1)
        Kf = (lambda x, *a, **k: torch.fft.rfft(x.float(), *a, **k))(K, L2)
        Uf = (lambda x, *a, **k: torch.fft.rfft(x.float(), *a, **k))(u_t, L2)
        y = (lambda x, *a, **k: torch.fft.irfft(x, *a, **k).to(torch.bfloat16))(Uf * Kf[None, :, :], L2)[:, :, :L]
        y = (lambda x, *d: x.permute(*d))(y, 0, 2, 1)
        return y + u * D_skip[None, None, :]

    def _B_ref(x, w1, w2):
        h = torch.einsum("bsd,df->bsf", x, w1)
        h = _silu(h)
        out = torch.einsum("bsf,fd->bsd", h, w2)
        return out

    x = A_u
    h = x + _A_ref(_layernorm(x, axis=-1), A_log_A_real, A_A_imag, A_C_real, A_C_imag, A_log_dt, A_D_skip)
    h2 = h + _B_ref(_layernorm(h, axis=-1), B_w1, B_w2)
    return h2
```

```asm
; @launch grid=(256,1,1) block=(256,1,1) lds=163840
.amdgcn_target "amdgcn-amd-amdhsa--gfx950"
.text
.globl sequential_preLN__ssm_conv_s4d__dense_activation_silu__prompt_kernel
.p2align 8
.type sequential_preLN__ssm_conv_s4d__dense_activation_silu__prompt_kernel,@function
sequential_preLN__ssm_conv_s4d__dense_activation_silu__prompt_kernel:
  s_cmp_ge_u32 s2, 256
  s_cbranch_scc1 K_end
  s_load_dwordx16 s[36:51], s[0:1], 0
  s_load_dwordx8 s[52:59], s[0:1], 64
  s_load_dwordx2 s[60:61], s[0:1], 96
  s_lshr_b32 s80, s2, 3
  s_cmp_ge_u32 s80, 1
  s_cbranch_scc1 CP_skip
  s_getpc_b64 s[82:83]
CP_pc:
  s_and_b32 s80, s80, 1
  s_lshl_b32 s80, s80, 8
  v_add_u32 v252, s80, v0
  v_lshlrev_b32 v252, 7, v252
  v_min_u32 v252, K_end-CP_pc, v252
  v_mov_b32 v253, s83
  v_add_co_u32 v252, vcc, s82, v252
  s_nop 1
  v_addc_co_u32 v253, vcc, 0, v253, vcc
  global_load_dword v254, v[252:253], off
CP_skip:
  s_mov_b32 s90, 0x3f803f80
  s_mov_b32 s91, 0xffff0000
  v_lshrrev_b32 v1, 6, v0
  s_nop 0
  v_readfirstlane_b32 s28, v1
  s_and_b32 s80, s2, 7
  s_lshr_b32 s81, s2, 3
  s_mul_i32 s30, s80, 28
  s_add_u32 s30, s30, s81
  s_lshl_b32 s80, s80, 1
  s_and_b32 s81, s81, 1
  s_add_u32 s31, s80, s81
  s_lshr_b32 s32, s2, 4
  s_lshl_b32 s34, s31, 1
  s_and_b32 s80, s32, 1
  s_add_u32 s34, s34, s80
  s_lshr_b32 s35, s32, 1
  s_lshl_b32 s80, s30, 2
  s_mov_b32 s81, 15859712
  s_waitcnt lgkmcnt(0)
  s_load_dword s29, s[60:61], s81
  s_mov_b32 s100, s56
  s_mov_b32 s101, s57
  s_mov_b32 s8, s60
  s_mov_b32 s9, s61
  s_mov_b32 s10, 16777216
  s_mov_b32 s11, 0x20000
  s_mov_b32 s20, s52
  s_mov_b32 s21, s53
  s_mov_b32 s22, 1605632
  s_mov_b32 s23, 0x20000
  s_cmp_ge_u32 s2, 224
  s_cbranch_scc1 SP_entry
  s_load_dword s33, s[48:49], s80
  v_and_b32 v75, 63, v0
  v_lshlrev_b32 v75, 2, v75
  s_lshl_b32 s80, s30, 10
  s_lshl_b32 s81, s28, 8
  s_add_u32 s80, s80, s81
  s_mov_b32 s4, s38
  s_mov_b32 s5, s39
  s_mov_b32 s6, 229376
  s_mov_b32 s7, 0x20000
  buffer_load_dword v70, v75, s[4:7], s80 offen
  s_mov_b32 s4, s40
  s_mov_b32 s5, s41
  s_mov_b32 s6, 229376
  s_mov_b32 s7, 0x20000
  buffer_load_dword v71, v75, s[4:7], s80 offen
  s_mov_b32 s4, s42
  s_mov_b32 s5, s43
  s_mov_b32 s6, 229376
  s_mov_b32 s7, 0x20000
  buffer_load_dword v72, v75, s[4:7], s80 offen
  s_mov_b32 s4, s44
  s_mov_b32 s5, s45
  s_mov_b32 s6, 229376
  s_mov_b32 s7, 0x20000
  buffer_load_dword v73, v75, s[4:7], s80 offen
  s_mov_b32 s4, s46
  s_mov_b32 s5, s47
  s_mov_b32 s6, 896
  s_mov_b32 s7, 0x20000
  s_lshl_b32 s80, s30, 2
  v_mov_b32 v75, 0
  buffer_load_dword v74, v75, s[4:7], s80 offen
  s_mov_b32 s4, s36
  s_mov_b32 s5, s37
  s_mov_b32 s6, 1835008
  s_mov_b32 s7, 0x20000
  s_lshl_b32 s80, s2, 2
  s_add_u32 s80, s80, s28
  s_mul_i32 s80, s80, 1792
  v_and_b32 v216, 63, v0
  v_cmp_gt_u32 vcc, 56, v216
  v_lshlrev_b32 v216, 4, v216
  v_mov_b32 v217, 1073741824
  v_cndmask_b32 v216, v217, v216, vcc
  buffer_load_dwordx4 v[208:211], v216, s[4:7], s80 offen
  buffer_load_dwordx4 v[212:215], v216, s[4:7], s80 offen offset:896
  v_lshrrev_b32 v1, 6, v0
  v_lshlrev_b32 v1, 8, v1
  v_and_b32 v207, 63, v0
  v_add_u32 v1, v1, v207
  v_mul_u32_u24 v1, 1792, v1
  s_lshl_b32 s78, s30, 2
  buffer_load_dword v200, v1, s[4:7], s78 offen
  s_add_u32 s12, s60, 4194304
  s_addc_u32 s13, s61, 0
  s_mov_b32 s14, 1835008
  s_mov_b32 s15, 0x20000
  s_add_u32 s16, s60, 6291456
  s_addc_u32 s17, s61, 0
  s_mov_b32 s18, 7340032
  s_mov_b32 s19, 0x20000
  s_mov_b32 s24, s54
  s_mov_b32 s25, s55
  s_mov_b32 s26, 1605632
  s_mov_b32 s27, 0x20000
  v_mov_b32 v4, 0
  v_mov_b32 v5, 0
  v_lshlrev_b32 v3, 3, v0
  ds_write_b64 v3, v[4:5] offset:0
  v_and_b32 v8, 63, v0
  v_lshrrev_b32 v9, 4, v8
  v_and_b32 v10, 15, v8
  v_lshlrev_b32 v11, 2, v9
  v_xor_b32 v10, v10, v11
  v_lshlrev_b32 v10, 4, v10
  v_mul_u32_u24 v240, 3584, v9
  v_add_u32 v240, v240, v10
  v_lshl_add_u32 v241, v9, 8, v10
  s_mul_i32 s70, s28, 57344
  s_lshl_b32 s80, s32, 8
  s_add_u32 s70, s70, s80
  s_mul_i32 s71, s31, 114688
  s_lshl_b32 s72, s28, 12
  s_add_u32 s71, s71, s72
  s_lshr_b32 s73, s28, 1
  s_and_b32 s74, s28, 1
  v_and_b32 v8, 63, v0
  v_lshlrev_b32 v247, 4, v8
  s_lshl_b32 s80, s35, 2
  s_add_u32 s80, s80, s28
  s_mul_i32 s3, s80, 57344
  s_lshl_b32 s80, s80, 7
  s_add_u32 s80, s80, 15761408
  v_mov_b32 v248, s80
  s_lshr_b32 s80, s2, 3
  s_lshl_b32 s81, s80, 15
  v_lshlrev_b32 v250, 7, v0
  v_add_u32 v250, s81, v250
  s_mul_i32 s80, s80, 24576
  s_add_u32 s80, s80, 917504
  v_lshlrev_b32 v252, 7, v0
  v_add_u32 v252, s80, v252
  s_waitcnt vmcnt(3)
  s_lshr_b32 s80, s28, 1
  s_lshl_b32 s80, s80, 4
  s_sub_u32 s80, 16, s80
  v_lshlrev_b32 v80, s80, v74
  v_and_b32 v80, s91, v80
  s_mov_b32 s81, 0x3fb8aa3b
  v_mul_f32 v80, s81, v80
  v_exp_f32 v80, v80
  s_nop 0
  v_cvt_pk_bf16_f32 v80, v80, v80
  v_and_b32 v80, s91, v80
  s_mov_b32 s82, 0x3e22f983
  v_lshlrev_b32 v82, 16, v70
  v_lshlrev_b32 v83, 16, v71
  v_lshlrev_b32 v84, 16, v72
  v_lshlrev_b32 v85, 16, v73
  v_mul_f32 v82, s81, v82
  v_exp_f32 v82, v82
  v_and_b32 v106, s91, v70
  v_and_b32 v107, s91, v71
  v_and_b32 v108, s91, v72
  v_and_b32 v109, s91, v73
  v_mul_f32 v106, s81, v106
  v_exp_f32 v106, v106
  s_nop 0
  v_cvt_pk_bf16_f32 v100, v82, v106
  v_lshlrev_b32 v82, 16, v100
  v_and_b32 v106, s91, v100
  v_mul_f32 v82, v80, v82
  v_mul_f32 v83, v80, v83
  v_mul_f32 v84, v80, v84
  v_mul_f32 v85, v80, v85
  v_add_f32 v84, v84, v84
  v_add_f32 v85, v85, v85
  v_mul_f32 v106, v80, v106
  v_mul_f32 v107, v80, v107
  v_mul_f32 v108, v80, v108
  v_mul_f32 v109, v80, v109
  v_add_f32 v108, v108, v108
  v_add_f32 v109, v109, v109
  s_mov_b32 s83, 0xbf800000
  s_mov_b32 s84, 0x3f800000
  v_mul_f32 v100, s83, v82
  v_mul_f32 v101, s84, v83
  v_mul_f32 v124, s83, v106
  v_mul_f32 v125, s84, v107
  v_mul_f32 v100, s81, v100
  v_mul_f32 v101, s82, v101
  v_mul_f32 v124, s81, v124
  v_mul_f32 v125, s82, v125
  v_exp_f32 v100, v100
  v_fract_f32 v101, v101
  v_exp_f32 v124, v124
  v_fract_f32 v125, v125
  v_cos_f32 v86, v101
  v_sin_f32 v87, v101
  v_cos_f32 v110, v125
  v_sin_f32 v111, v125
  v_pk_mul_f32 v[86:87], v[86:87], v[100:101] op_sel_hi:[1,0]
  v_pk_mul_f32 v[110:111], v[110:111], v[124:125] op_sel_hi:[1,0]
  s_mov_b32 s83, 0xc1000000
  s_mov_b32 s84, 0x41000000
  v_mul_f32 v100, s83, v82
  v_mul_f32 v101, s84, v83
  v_mul_f32 v124, s83, v106
  v_mul_f32 v125, s84, v107
  v_mul_f32 v100, s81, v100
  v_mul_f32 v101, s82, v101
  v_mul_f32 v124, s81, v124
  v_mul_f32 v125, s82, v125
  v_exp_f32 v100, v100
  v_fract_f32 v101, v101
  v_exp_f32 v124, v124
  v_fract_f32 v125, v125
  v_cos_f32 v88, v101
  v_sin_f32 v89, v101
  v_cos_f32 v112, v125
  v_sin_f32 v113, v125
  v_pk_mul_f32 v[88:89], v[88:89], v[100:101] op_sel_hi:[1,0]
  v_pk_mul_f32 v[112:113], v[112:113], v[124:125] op_sel_hi:[1,0]
  s_mov_b32 s83, 0xc3800000
  s_mov_b32 s84, 0x43800000
  v_mul_f32 v100, s83, v82
  v_mul_f32 v101, s84, v83
  v_mul_f32 v124, s83, v106
  v_mul_f32 v125, s84, v107
  v_mul_f32 v100, s81, v100
  v_mul_f32 v101, s82, v101
  v_mul_f32 v124, s81, v124
  v_mul_f32 v125, s82, v125
  v_exp_f32 v100, v100
  v_fract_f32 v101, v101
  v_exp_f32 v124, v124
  v_fract_f32 v125, v125
  v_cos_f32 v90, v101
  v_sin_f32 v91, v101
  v_cos_f32 v114, v125
  v_sin_f32 v115, v125
  v_pk_mul_f32 v[90:91], v[90:91], v[100:101] op_sel_hi:[1,0]
  v_pk_mul_f32 v[114:115], v[114:115], v[124:125] op_sel_hi:[1,0]
  s_waitcnt vmcnt(1) lgkmcnt(0)
  s_mul_i32 s29, s29, 0x9E3779B1
  s_add_u32 s29, s29, 0x7F4A7C15
  v_mov_b32 v216, 0
  v_mov_b32 v217, 0
  v_mov_b32 v218, 0
  v_mov_b32 v219, 0
  v_dot2_f32_bf16 v216, v208, s90, v216
  v_dot2_f32_bf16 v217, v212, s90, v217
  v_dot2_f32_bf16 v218, v208, v208, v218
  v_dot2_f32_bf16 v219, v212, v212, v219
  v_dot2_f32_bf16 v216, v209, s90, v216
  v_dot2_f32_bf16 v217, v213, s90, v217
  v_dot2_f32_bf16 v218, v209, v209, v218
  v_dot2_f32_bf16 v219, v213, v213, v219
  v_dot2_f32_bf16 v216, v210, s90, v216
  v_dot2_f32_bf16 v217, v214, s90, v217
  v_dot2_f32_bf16 v218, v210, v210, v218
  v_dot2_f32_bf16 v219, v214, v214, v219
  v_dot2_f32_bf16 v216, v211, s90, v216
  v_dot2_f32_bf16 v217, v215, s90, v217
  v_dot2_f32_bf16 v218, v211, v211, v218
  v_dot2_f32_bf16 v219, v215, v215, v219
  v_add_f32_dpp v216, v216, v216 row_ror:8 row_mask:0xf bank_mask:0xf
  v_add_f32_dpp v217, v217, v217 row_ror:8 row_mask:0xf bank_mask:0xf
  v_add_f32_dpp v218, v218, v218 row_ror:8 row_mask:0xf bank_mask:0xf
  v_add_f32_dpp v219, v219, v219 row_ror:8 row_mask:0xf bank_mask:0xf
  v_add_f32_dpp v216, v216, v216 row_ror:4 row_mask:0xf bank_mask:0xf
  v_add_f32_dpp v217, v217, v217 row_ror:4 row_mask:0xf bank_mask:0xf
  v_add_f32_dpp v218, v218, v218 row_ror:4 row_mask:0xf bank_mask:0xf
  v_add_f32_dpp v219, v219, v219 row_ror:4 row_mask:0xf bank_mask:0xf
  v_add_f32_dpp v216, v216, v216 row_ror:2 row_mask:0xf bank_mask:0xf
  v_add_f32_dpp v217, v217, v217 row_ror:2 row_mask:0xf bank_mask:0xf
  v_add_f32_dpp v218, v218, v218 row_ror:2 row_mask:0xf bank_mask:0xf
  v_add_f32_dpp v219, v219, v219 row_ror:2 row_mask:0xf bank_mask:0xf
  v_add_f32_dpp v216, v216, v216 row_ror:1 row_mask:0xf bank_mask:0xf
  v_add_f32_dpp v217, v217, v217 row_ror:1 row_mask:0xf bank_mask:0xf
  v_add_f32_dpp v218, v218, v218 row_ror:1 row_mask:0xf bank_mask:0xf
  v_add_f32_dpp v219, v219, v219 row_ror:1 row_mask:0xf bank_mask:0xf
  v_mov_b32 v220, v216
  v_mov_b32 v221, v217
  v_mov_b32 v222, v218
  v_mov_b32 v223, v219
  v_permlane16_swap_b32 v220, v216
  v_permlane16_swap_b32 v221, v217
  v_permlane16_swap_b32 v222, v218
  v_permlane16_swap_b32 v223, v219
  v_add_f32 v216, v216, v220
  v_add_f32 v217, v217, v221
  v_add_f32 v218, v218, v222
  v_add_f32 v219, v219, v223
  v_mov_b32 v220, v216
  v_mov_b32 v221, v217
  v_mov_b32 v222, v218
  v_mov_b32 v223, v219
  v_permlane32_swap_b32 v220, v216
  v_permlane32_swap_b32 v221, v217
  v_permlane32_swap_b32 v222, v218
  v_permlane32_swap_b32 v223, v219
  v_add_f32 v216, v216, v220
  v_add_f32 v217, v217, v221
  v_add_f32 v218, v218, v222
  v_add_f32 v219, v219, v223
  s_mov_b32 s88, 0x3b124925
  s_mov_b32 s89, 0x3727c5ac
  v_mul_f32 v216, s88, v216
  v_mul_f32 v217, s88, v217
  v_mul_f32 v218, s88, v218
  v_mul_f32 v219, s88, v219
  v_fma_f32 v218, -v216, v216, v218
  v_fma_f32 v219, -v217, v217, v219
  v_max_f32 v218, 0, v218
  v_max_f32 v219, 0, v219
  v_cvt_pk_bf16_f32 v222, v216, v217
  v_lshlrev_b32 v208, 16, v222
  v_and_b32 v209, s91, v222
  v_cvt_pk_bf16_f32 v222, v218, v219
  v_lshlrev_b32 v220, 16, v222
  v_and_b32 v221, s91, v222
  v_add_f32 v220, s89, v220
  v_add_f32 v221, s89, v221
  v_cvt_pk_bf16_f32 v222, v220, v221
  v_lshlrev_b32 v220, 16, v222
  v_and_b32 v221, s91, v222
  v_sqrt_f32 v220, v220
  v_sqrt_f32 v221, v221
  s_nop 0
  v_cvt_pk_bf16_f32 v222, v220, v221
  v_lshlrev_b32 v220, 16, v222
  v_and_b32 v221, s91, v222
  s_lshl_b32 s80, s2, 2
  s_add_u32 s80, s80, s28
  s_lshl_b32 s80, s80, 4
  s_add_u32 s80, s80, 15728640
  v_lshrrev_b32 v208, 16, v208
  v_or_b32 v212, v208, v220
  v_lshrrev_b32 v209, 16, v209
  v_or_b32 v213, v209, v221
  v_mov_b32 v214, s29
  v_mov_b32 v215, 0
  v_mov_b32 v216, 0
  s_mov_b64 exec, 1
  buffer_store_dwordx4 v[212:215], v216, s[8:11], s80 offen sc1
  s_mov_b64 exec, -1
  buffer_load_dword v201, v1, s[4:7], s78 offen  offset:896
  s_add_u32 s78, s78, 114688
  buffer_load_dword v202, v1, s[4:7], s78 offen
  v_and_b32 v81, 63, v0
  v_lshlrev_b32 v81, 3, v81
  s_mul_i32 s80, s28, 33792
  s_add_u32 s80, s80, 18432
  v_add_u32 v81, s80, v81
  v_pk_mul_f32 v[100:101], v[86:87], v[86:87] op_sel:[1,1] op_sel_hi:[1,0] neg_lo:[0,1]
  v_pk_mul_f32 v[124:125], v[110:111], v[110:111] op_sel:[1,1] op_sel_hi:[1,0] neg_lo:[0,1]
  v_pk_fma_f32 v[92:93], v[86:87], v[86:87], v[100:101] op_sel:[0,0,0] op_sel_hi:[0,1,1]
  v_pk_fma_f32 v[116:117], v[110:111], v[110:111], v[124:125] op_sel:[0,0,0] op_sel_hi:[0,1,1]
  v_cvt_pk_bf16_f32 v130, v84, v85
  v_cvt_pk_bf16_f32 v131, v108, v109
  ds_write_b64 v81, v[130:131] offset:0
  v_pk_mul_f32 v[100:101], v[92:93], v[92:93] op_sel:[1,1] op_sel_hi:[1,0] neg_lo:[0,1]
  v_pk_mul_f32 v[124:125], v[116:117], v[116:117] op_sel:[1,1] op_sel_hi:[1,0] neg_lo:[0,1]
  v_pk_mul_f32 v[102:103], v[84:85], v[86:87] op_sel:[1,1] op_sel_hi:[1,0] neg_lo:[0,1]
  v_pk_mul_f32 v[126:127], v[108:109], v[110:111] op_sel:[1,1] op_sel_hi:[1,0] neg_lo:[0,1]
  v_pk_fma_f32 v[94:95], v[92:93], v[92:93], v[100:101] op_sel:[0,0,0] op_sel_hi:[0,1,1]
  v_pk_fma_f32 v[118:119], v[116:117], v[116:117], v[124:125] op_sel:[0,0,0] op_sel_hi:[0,1,1]
  v_pk_fma_f32 v[96:97], v[84:85], v[86:87], v[102:103] op_sel:[0,0,0] op_sel_hi:[0,1,1]
  v_pk_fma_f32 v[120:121], v[108:109], v[110:111], v[126:127] op_sel:[0,0,0] op_sel_hi:[0,1,1]
  v_cvt_pk_bf16_f32 v132, v96, v97
  v_cvt_pk_bf16_f32 v133, v120, v121
  ds_write_b64 v81, v[132:133] offset:528
  v_mov_b32 v98, 1.0
  v_mov_b32 v99, 0
  v_mov_b32 v122, 1.0
  v_mov_b32 v123, 0
  v_cvt_pk_bf16_f32 v134, v98, v99
  v_cvt_pk_bf16_f32 v135, v122, v123
  ds_write_b64 v81, v[134:135] offset:16896
  v_mov_b32 v98, v88
  v_sub_f32 v99, 0, v89
  v_mov_b32 v82, v88
  v_sub_f32 v83, 0, v89
  v_mov_b32 v122, v112
  v_sub_f32 v123, 0, v113
  v_mov_b32 v106, v112
  v_sub_f32 v107, 0, v113
  v_cvt_pk_bf16_f32 v136, v98, v99
  v_cvt_pk_bf16_f32 v137, v122, v123
  ds_write_b64 v81, v[136:137] offset:17424
  v_pk_mul_f32 v[100:101], v[98:99], v[82:83] op_sel:[1,1] op_sel_hi:[1,0] neg_lo:[0,1]
  v_pk_mul_f32 v[124:125], v[122:123], v[106:107] op_sel:[1,1] op_sel_hi:[1,0] neg_lo:[0,1]
  v_pk_mul_f32 v[102:103], v[96:97], v[86:87] op_sel:[1,1] op_sel_hi:[1,0] neg_lo:[0,1]
  v_pk_mul_f32 v[126:127], v[120:121], v[110:111] op_sel:[1,1] op_sel_hi:[1,0] neg_lo:[0,1]
  v_pk_fma_f32 v[98:99], v[98:99], v[82:83], v[100:101] op_sel:[0,0,0] op_sel_hi:[0,1,1]
  v_pk_fma_f32 v[122:123], v[122:123], v[106:107], v[124:125] op_sel:[0,0,0] op_sel_hi:[0,1,1]
  v_pk_fma_f32 v[96:97], v[96:97], v[86:87], v[102:103] op_sel:[0,0,0] op_sel_hi:[0,1,1]
  v_pk_fma_f32 v[120:121], v[120:121], v[110:111], v[126:127] op_sel:[0,0,0] op_sel_hi:[0,1,1]
  v_cvt_pk_bf16_f32 v130, v98, v99
  v_cvt_pk_bf16_f32 v131, v122, v123
  ds_write_b64 v81, v[130:131] offset:17952
  v_cvt_pk_bf16_f32 v132, v96, v97
  v_cvt_pk_bf16_f32 v133, v120, v121
  ds_write_b64 v81, v[132:133] offset:1056
  v_pk_mul_f32 v[100:101], v[98:99], v[82:83] op_sel:[1,1] op_sel_hi:[1,0] neg_lo:[0,1]
  v_pk_mul_f32 v[124:125], v[122:123], v[106:107] op_sel:[1,1] op_sel_hi:[1,0] neg_lo:[0,1]
  v_pk_mul_f32 v[102:103], v[96:97], v[86:87] op_sel:[1,1] op_sel_hi:[1,0] neg_lo:[0,1]
  v_pk_mul_f32 v[126:127], v[120:121], v[110:111] op_sel:[1,1] op_sel_hi:[1,0] neg_lo:[0,1]
  v_pk_fma_f32 v[98:99], v[98:99], v[82:83], v[100:101] op_sel:[0,0,0] op_sel_hi:[0,1,1]
  v_pk_fma_f32 v[122:123], v[122:123], v[106:107], v[124:125] op_sel:[0,0,0] op_sel_hi:[0,1,1]
  v_pk_fma_f32 v[96:97], v[96:97], v[86:87], v[102:103] op_sel:[0,0,0] op_sel_hi:[0,1,1]
  v_pk_fma_f32 v[120:121], v[120:121], v[110:111], v[126:127] op_sel:[0,0,0] op_sel_hi:[0,1,1]
  v_cvt_pk_bf16_f32 v134, v98, v99
  v_cvt_pk_bf16_f32 v135, v122, v123
  ds_write_b64 v81, v[134:135] offset:18480
  v_cvt_pk_bf16_f32 v136, v96, v97
  v_cvt_pk_bf16_f32 v137, v120, v121
  ds_write_b64 v81, v[136:137] offset:1584
  v_pk_mul_f32 v[100:101], v[98:99], v[82:83] op_sel:[1,1] op_sel_hi:[1,0] neg_lo:[0,1]
  v_pk_mul_f32 v[124:125], v[122:123], v[106:107] op_sel:[1,1] op_sel_hi:[1,0] neg_lo:[0,1]
  v_pk_mul_f32 v[102:103], v[96:97], v[86:87] op_sel:[1,1] op_sel_hi:[1,0] neg_lo:[0,1]
  v_pk_mul_f32 v[126:127], v[120:121], v[110:111] op_sel:[1,1] op_sel_hi:[1,0] neg_lo:[0,1]
  v_pk_fma_f32 v[98:99], v[98:99], v[82:83], v[100:101] op_sel:[0,0,0] op_sel_hi:[0,1,1]
  v_pk_fma_f32 v[122:123], v[122:123], v[106:107], v[124:125] op_sel:[0,0,0] op_sel_hi:[0,1,1]
  v_pk_fma_f32 v[96:97], v[96:97], v[86:87], v[102:103] op_sel:[0,0,0] op_sel_hi:[0,1,1]
  v_pk_fma_f32 v[120:121], v[120:121], v[110:111], v[126:127] op_sel:[0,0,0] op_sel_hi:[0,1,1]
  v_cvt_pk_bf16_f32 v130, v98, v99
  v_cvt_pk_bf16_f32 v131, v122, v123
  ds_write_b64 v81, v[130:131] offset:19008
  v_cvt_pk_bf16_f32 v132, v96, v97
  v_cvt_pk_bf16_f32 v133, v120, v121
  ds_write_b64 v81, v[132:133] offset:2112
  buffer_load_dword v203, v1, s[4:7], s78 offen  offset:896
  v_pk_mul_f32 v[100:101], v[98:99], v[82:83] op_sel:[1,1] op_sel_hi:[1,0] neg_lo:[0,1]
  v_pk_mul_f32 v[124:125], v[122:123], v[106:107] op_sel:[1,1] op_sel_hi:[1,0] neg_lo:[0,1]
  v_pk_mul_f32 v[102:103], v[96:97], v[86:87] op_sel:[1,1] op_sel_hi:[1,0] neg_lo:[0,1]
  v_pk_mul_f32 v[126:127], v[120:121], v[110:111] op_sel:[1,1] op_sel_hi:[1,0] neg_lo:[0,1]
  v_pk_fma_f32 v[98:99], v[98:99], v[82:83], v[100:101] op_sel:[0,0,0] op_sel_hi:[0,1,1]
  v_pk_fma_f32 v[122:123], v[122:123], v[106:107], v[124:125] op_sel:[0,0,0] op_sel_hi:[0,1,1]
  v_pk_fma_f32 v[96:97], v[96:97], v[86:87], v[102:103] op_sel:[0,0,0] op_sel_hi:[0,1,1]
  v_pk_fma_f32 v[120:121], v[120:121], v[110:111], v[126:127] op_sel:[0,0,0] op_sel_hi:[0,1,1]
  v_cvt_pk_bf16_f32 v134, v98, v99
  v_cvt_pk_bf16_f32 v135, v122, v123
  ds_write_b64 v81, v[134:135] offset:19536
  v_cvt_pk_bf16_f32 v136, v96, v97
  v_cvt_pk_bf16_f32 v137, v120, v121
  ds_write_b64 v81, v[136:137] offset:2640
  v_pk_mul_f32 v[100:101], v[98:99], v[82:83] op_sel:[1,1] op_sel_hi:[1,0] neg_lo:[0,1]
  v_pk_mul_f32 v[124:125], v[122:123], v[106:107] op_sel:[1,1] op_sel_hi:[1,0] neg_lo:[0,1]
  v_pk_mul_f32 v[102:103], v[96:97], v[86:87] op_sel:[1,1] op_sel_hi:[1,0] neg_lo:[0,1]
  v_pk_mul_f32 v[126:127], v[120:121], v[110:111] op_sel:[1,1] op_sel_hi:[1,0] neg_lo:[0,1]
  v_pk_fma_f32 v[98:99], v[98:99], v[82:83], v[100:101] op_sel:[0,0,0] op_sel_hi:[0,1,1]
  v_pk_fma_f32 v[122:123], v[122:123], v[106:107], v[124:125] op_sel:[0,0,0] op_sel_hi:[0,1,1]
  v_pk_fma_f32 v[96:97], v[96:97], v[86:87], v[102:103] op_sel:[0,0,0] op_sel_hi:[0,1,1]
  v_pk_fma_f32 v[120:121], v[120:121], v[110:111], v[126:127] op_sel:[0,0,0] op_sel_hi:[0,1,1]
  v_cvt_pk_bf16_f32 v130, v98, v99
  v_cvt_pk_bf16_f32 v131, v122, v123
  ds_write_b64 v81, v[130:131] offset:20064
  v_cvt_pk_bf16_f32 v132, v96, v97
  v_cvt_pk_bf16_f32 v133, v120, v121
  ds_write_b64 v81, v[132:133] offset:3168
  v_pk_mul_f32 v[100:101], v[98:99], v[82:83] op_sel:[1,1] op_sel_hi:[1,0] neg_lo:[0,1]
  v_pk_mul_f32 v[124:125], v[122:123], v[106:107] op_sel:[1,1] op_sel_hi:[1,0] neg_lo:[0,1]
  v_pk_mul_f32 v[102:103], v[96:97], v[86:87] op_sel:[1,1] op_sel_hi:[1,0] neg_lo:[0,1]
  v_pk_mul_f32 v[126:127], v[120:121], v[110:111] op_sel:[1,1] op_sel_hi:[1,0] neg_lo:[0,1]
  v_pk_fma_f32 v[98:99], v[98:99], v[82:83], v[100:101] op_sel:[0,0,0] op_sel_hi:[0,1,1]
  v_pk_fma_f32 v[122:123], v[122:123], v[106:107], v[124:125] op_sel:[0,0,0] op_sel_hi:[0,1,1]
  v_pk_fma_f32 v[96:97], v[96:97], v[86:87], v[102:103] op_sel:[0,0,0] op_sel_hi:[0,1,1]
  v_pk_fma_f32 v[120:121], v[120:121], v[110:111], v[126:127] op_sel:[0,0,0] op_sel_hi:[0,1,1]
  v_cvt_pk_bf16_f32 v134, v98, v99
  v_cvt_pk_bf16_f32 v135, v122, v123
  ds_write_b64 v81, v[134:135] offset:20592
  v_cvt_pk_bf16_f32 v136, v96, v97
  v_cvt_pk_bf16_f32 v137, v120, v121
  ds_write_b64 v81, v[136:137] offset:3696
  v_pk_mul_f32 v[100:101], v[98:99], v[82:83] op_sel:[1,1] op_sel_hi:[1,0] neg_lo:[0,1]
  v_pk_mul_f32 v[124:125], v[122:123], v[106:107] op_sel:[1,1] op_sel_hi:[1,0] neg_lo:[0,1]
  v_pk_mul_f32 v[102:103], v[84:85], v[90:91] op_sel:[1,1] op_sel_hi:[1,0] neg_lo:[0,1]
  v_pk_mul_f32 v[126:127], v[108:109], v[114:115] op_sel:[1,1] op_sel_hi:[1,0] neg_lo:[0,1]
  v_pk_fma_f32 v[98:99], v[98:99], v[82:83], v[100:101] op_sel:[0,0,0] op_sel_hi:[0,1,1]
  v_pk_fma_f32 v[122:123], v[122:123], v[106:107], v[124:125] op_sel:[0,0,0] op_sel_hi:[0,1,1]
  v_pk_fma_f32 v[84:85], v[84:85], v[90:91], v[102:103] op_sel:[0,0,0] op_sel_hi:[0,1,1]
  v_pk_fma_f32 v[108:109], v[108:109], v[114:115], v[126:127] op_sel:[0,0,0] op_sel_hi:[0,1,1]
  v_cvt_pk_bf16_f32 v130, v98, v99
  v_cvt_pk_bf16_f32 v131, v122, v123
  ds_write_b64 v81, v[130:131] offset:21120
  v_cvt_pk_bf16_f32 v132, v84, v85
  v_cvt_pk_bf16_f32 v133, v108, v109
  ds_write_b64 v81, v[132:133] offset:4224
  s_add_u32 s78, s78, 114688
  buffer_load_dword v204, v1, s[4:7], s78 offen
  v_pk_mul_f32 v[100:101], v[98:99], v[82:83] op_sel:[1,1] op_sel_hi:[1,0] neg_lo:[0,1]
  v_pk_mul_f32 v[124:125], v[122:123], v[106:107] op_sel:[1,1] op_sel_hi:[1,0] neg_lo:[0,1]
  v_pk_mul_f32 v[102:103], v[84:85], v[92:93] op_sel:[1,1] op_sel_hi:[1,0] neg_lo:[0,1]
  v_pk_mul_f32 v[126:127], v[108:109], v[116:117] op_sel:[1,1] op_sel_hi:[1,0] neg_lo:[0,1]
  v_pk_fma_f32 v[98:99], v[98:99], v[82:83], v[100:101] op_sel:[0,0,0] op_sel_hi:[0,1,1]
  v_pk_fma_f32 v[122:123], v[122:123], v[106:107], v[124:125] op_sel:[0,0,0] op_sel_hi:[0,1,1]
  v_pk_fma_f32 v[96:97], v[84:85], v[92:93], v[102:103] op_sel:[0,0,0] op_sel_hi:[0,1,1]
  v_pk_fma_f32 v[120:121], v[108:109], v[116:117], v[126:127] op_sel:[0,0,0] op_sel_hi:[0,1,1]
  v_cvt_pk_bf16_f32 v134, v98, v99
  v_cvt_pk_bf16_f32 v135, v122, v123
  ds_write_b64 v81, v[134:135] offset:21648
  v_cvt_pk_bf16_f32 v136, v96, v97
  v_cvt_pk_bf16_f32 v137, v120, v121
  ds_write_b64 v81, v[136:137] offset:4752
  v_pk_mul_f32 v[100:101], v[98:99], v[82:83] op_sel:[1,1] op_sel_hi:[1,0] neg_lo:[0,1]
  v_pk_mul_f32 v[124:125], v[122:123], v[106:107] op_sel:[1,1] op_sel_hi:[1,0] neg_lo:[0,1]
  v_pk_mul_f32 v[102:103], v[96:97], v[92:93] op_sel:[1,1] op_sel_hi:[1,0] neg_lo:[0,1]
  v_pk_mul_f32 v[126:127], v[120:121], v[116:117] op_sel:[1,1] op_sel_hi:[1,0] neg_lo:[0,1]
  v_pk_fma_f32 v[98:99], v[98:99], v[82:83], v[100:101] op_sel:[0,0,0] op_sel_hi:[0,1,1]
  v_pk_fma_f32 v[122:123], v[122:123], v[106:107], v[124:125] op_sel:[0,0,0] op_sel_hi:[0,1,1]
  v_pk_fma_f32 v[96:97], v[96:97], v[92:93], v[102:103] op_sel:[0,0,0] op_sel_hi:[0,1,1]
  v_pk_fma_f32 v[120:121], v[120:121], v[116:117], v[126:127] op_sel:[0,0,0] op_sel_hi:[0,1,1]
  v_cvt_pk_bf16_f32 v130, v98, v99
  v_cvt_pk_bf16_f32 v131, v122, v123
  ds_write_b64 v81, v[130:131] offset:22176
  v_cvt_pk_bf16_f32 v132, v96, v97
  v_cvt_pk_bf16_f32 v133, v120, v121
  ds_write_b64 v81, v[132:133] offset:5280
  ds_write_b64 v81, v[132:133] offset:6336
  v_pk_mul_f32 v[100:101], v[98:99], v[82:83] op_sel:[1,1] op_sel_hi:[1,0] neg_lo:[0,1]
  v_pk_mul_f32 v[124:125], v[122:123], v[106:107] op_sel:[1,1] op_sel_hi:[1,0] neg_lo:[0,1]
  v_pk_mul_f32 v[102:103], v[96:97], v[92:93] op_sel:[1,1] op_sel_hi:[1,0] neg_lo:[0,1]
  v_pk_mul_f32 v[126:127], v[120:121], v[116:117] op_sel:[1,1] op_sel_hi:[1,0] neg_lo:[0,1]
  v_pk_fma_f32 v[98:99], v[98:99], v[82:83], v[100:101] op_sel:[0,0,0] op_sel_hi:[0,1,1]
  v_pk_fma_f32 v[122:123], v[122:123], v[106:107], v[124:125] op_sel:[0,0,0] op_sel_hi:[0,1,1]
  v_pk_fma_f32 v[96:97], v[96:97], v[92:93], v[102:103] op_sel:[0,0,0] op_sel_hi:[0,1,1]
  v_pk_fma_f32 v[120:121], v[120:121], v[116:117], v[126:127] op_sel:[0,0,0] op_sel_hi:[0,1,1]
  v_cvt_pk_bf16_f32 v134, v98, v99
  v_cvt_pk_bf16_f32 v135, v122, v123
  ds_write_b64 v81, v[134:135] offset:22704
  v_cvt_pk_bf16_f32 v136, v96, v97
  v_cvt_pk_bf16_f32 v137, v120, v121
  ds_write_b64 v81, v[136:137] offset:6864
  v_pk_mul_f32 v[100:101], v[98:99], v[82:83] op_sel:[1,1] op_sel_hi:[1,0] neg_lo:[0,1]
  v_pk_mul_f32 v[124:125], v[122:123], v[106:107] op_sel:[1,1] op_sel_hi:[1,0] neg_lo:[0,1]
  v_pk_mul_f32 v[102:103], v[96:97], v[92:93] op_sel:[1,1] op_sel_hi:[1,0] neg_lo:[0,1]
  v_pk_mul_f32 v[126:127], v[120:121], v[116:117] op_sel:[1,1] op_sel_hi:[1,0] neg_lo:[0,1]
  v_pk_fma_f32 v[98:99], v[98:99], v[82:83], v[100:101] op_sel:[0,0,0] op_sel_hi:[0,1,1]
  v_pk_fma_f32 v[122:123], v[122:123], v[106:107], v[124:125] op_sel:[0,0,0] op_sel_hi:[0,1,1]
  v_pk_fma_f32 v[96:97], v[96:97], v[92:93], v[102:103] op_sel:[0,0,0] op_sel_hi:[0,1,1]
  v_pk_fma_f32 v[120:121], v[120:121], v[116:117], v[126:127] op_sel:[0,0,0] op_sel_hi:[0,1,1]
  v_cvt_pk_bf16_f32 v130, v98, v99
  v_cvt_pk_bf16_f32 v131, v122, v123
  ds_write_b64 v81, v[130:131] offset:23232
  v_cvt_pk_bf16_f32 v132, v96, v97
  v_cvt_pk_bf16_f32 v133, v120, v121
  ds_write_b64 v81, v[132:133] offset:7392
  buffer_load_dword v205, v1, s[4:7], s78 offen  offset:896
  v_pk_mul_f32 v[100:101], v[98:99], v[82:83] op_sel:[1,1] op_sel_hi:[1,0] neg_lo:[0,1]
  v_pk_mul_f32 v[124:125], v[122:123], v[106:107] op_sel:[1,1] op_sel_hi:[1,0] neg_lo:[0,1]
  v_pk_mul_f32 v[102:103], v[84:85], v[90:91] op_sel:[1,1] op_sel_hi:[1,0] neg_lo:[0,1]
  v_pk_mul_f32 v[126:127], v[108:109], v[114:115] op_sel:[1,1] op_sel_hi:[1,0] neg_lo:[0,1]
  v_pk_fma_f32 v[98:99], v[98:99], v[82:83], v[100:101] op_sel:[0,0,0] op_sel_hi:[0,1,1]
  v_pk_fma_f32 v[122:123], v[122:123], v[106:107], v[124:125] op_sel:[0,0,0] op_sel_hi:[0,1,1]
  v_pk_fma_f32 v[84:85], v[84:85], v[90:91], v[102:103] op_sel:[0,0,0] op_sel_hi:[0,1,1]
  v_pk_fma_f32 v[108:109], v[108:109], v[114:115], v[126:127] op_sel:[0,0,0] op_sel_hi:[0,1,1]
  v_cvt_pk_bf16_f32 v134, v98, v99
  v_cvt_pk_bf16_f32 v135, v122, v123
  ds_write_b64 v81, v[134:135] offset:23760
  v_cvt_pk_bf16_f32 v136, v84, v85
  v_cvt_pk_bf16_f32 v137, v108, v109
  ds_write_b64 v81, v[136:137] offset:8448
  v_pk_mul_f32 v[100:101], v[98:99], v[82:83] op_sel:[1,1] op_sel_hi:[1,0] neg_lo:[0,1]
  v_pk_mul_f32 v[124:125], v[122:123], v[106:107] op_sel:[1,1] op_sel_hi:[1,0] neg_lo:[0,1]
  v_pk_mul_f32 v[102:103], v[84:85], v[94:95] op_sel:[1,1] op_sel_hi:[1,0] neg_lo:[0,1]
  v_pk_mul_f32 v[126:127], v[108:109], v[118:119] op_sel:[1,1] op_sel_hi:[1,0] neg_lo:[0,1]
  v_pk_fma_f32 v[98:99], v[98:99], v[82:83], v[100:101] op_sel:[0,0,0] op_sel_hi:[0,1,1]
  v_pk_fma_f32 v[122:123], v[122:123], v[106:107], v[124:125] op_sel:[0,0,0] op_sel_hi:[0,1,1]
  v_pk_fma_f32 v[96:97], v[84:85], v[94:95], v[102:103] op_sel:[0,0,0] op_sel_hi:[0,1,1]
  v_pk_fma_f32 v[120:121], v[108:109], v[118:119], v[126:127] op_sel:[0,0,0] op_sel_hi:[0,1,1]
  v_cvt_pk_bf16_f32 v130, v98, v99
  v_cvt_pk_bf16_f32 v131, v122, v123
  ds_write_b64 v81, v[130:131] offset:24288
  v_cvt_pk_bf16_f32 v132, v96, v97
  v_cvt_pk_bf16_f32 v133, v120, v121
  ds_write_b64 v81, v[132:133] offset:8976
  ds_write_b64 v81, v[132:133] offset:10560
  v_pk_mul_f32 v[100:101], v[98:99], v[82:83] op_sel:[1,1] op_sel_hi:[1,0] neg_lo:[0,1]
  v_pk_mul_f32 v[124:125], v[122:123], v[106:107] op_sel:[1,1] op_sel_hi:[1,0] neg_lo:[0,1]
  v_pk_mul_f32 v[102:103], v[96:97], v[94:95] op_sel:[1,1] op_sel_hi:[1,0] neg_lo:[0,1]
  v_pk_mul_f32 v[126:127], v[120:121], v[118:119] op_sel:[1,1] op_sel_hi:[1,0] neg_lo:[0,1]
  v_pk_fma_f32 v[98:99], v[98:99], v[82:83], v[100:101] op_sel:[0,0,0] op_sel_hi:[0,1,1]
  v_pk_fma_f32 v[122:123], v[122:123], v[106:107], v[124:125] op_sel:[0,0,0] op_sel_hi:[0,1,1]
  v_pk_fma_f32 v[96:97], v[96:97], v[94:95], v[102:103] op_sel:[0,0,0] op_sel_hi:[0,1,1]
  v_pk_fma_f32 v[120:121], v[120:121], v[118:119], v[126:127] op_sel:[0,0,0] op_sel_hi:[0,1,1]
  v_cvt_pk_bf16_f32 v134, v98, v99
  v_cvt_pk_bf16_f32 v135, v122, v123
  ds_write_b64 v81, v[134:135] offset:24816
  v_cvt_pk_bf16_f32 v136, v96, v97
  v_cvt_pk_bf16_f32 v137, v120, v121
  ds_write_b64 v81, v[136:137] offset:11088
  v_pk_mul_f32 v[100:101], v[98:99], v[82:83] op_sel:[1,1] op_sel_hi:[1,0] neg_lo:[0,1]
  v_pk_mul_f32 v[124:125], v[122:123], v[106:107] op_sel:[1,1] op_sel_hi:[1,0] neg_lo:[0,1]
  v_pk_mul_f32 v[102:103], v[84:85], v[90:91] op_sel:[1,1] op_sel_hi:[1,0] neg_lo:[0,1]
  v_pk_mul_f32 v[126:127], v[108:109], v[114:115] op_sel:[1,1] op_sel_hi:[1,0] neg_lo:[0,1]
  v_pk_fma_f32 v[98:99], v[98:99], v[82:83], v[100:101] op_sel:[0,0,0] op_sel_hi:[0,1,1]
  v_pk_fma_f32 v[122:123], v[122:123], v[106:107], v[124:125] op_sel:[0,0,0] op_sel_hi:[0,1,1]
  v_pk_fma_f32 v[84:85], v[84:85], v[90:91], v[102:103] op_sel:[0,0,0] op_sel_hi:[0,1,1]
  v_pk_fma_f32 v[108:109], v[108:109], v[114:115], v[126:127] op_sel:[0,0,0] op_sel_hi:[0,1,1]
  v_cvt_pk_bf16_f32 v130, v98, v99
  v_cvt_pk_bf16_f32 v131, v122, v123
  ds_write_b64 v81, v[130:131] offset:25344
  v_cvt_pk_bf16_f32 v132, v84, v85
  v_cvt_pk_bf16_f32 v133, v108, v109
  ds_write_b64 v81, v[132:133] offset:9504
  s_add_u32 s78, s78, 114688
  buffer_load_dword v206, v1, s[4:7], s78 offen
  v_pk_mul_f32 v[100:101], v[98:99], v[82:83] op_sel:[1,1] op_sel_hi:[1,0] neg_lo:[0,1]
  v_pk_mul_f32 v[124:125], v[122:123], v[106:107] op_sel:[1,1] op_sel_hi:[1,0] neg_lo:[0,1]
  v_pk_mul_f32 v[102:103], v[84:85], v[94:95] op_sel:[1,1] op_sel_hi:[1,0] neg_lo:[0,1]
  v_pk_mul_f32 v[126:127], v[108:109], v[118:119] op_sel:[1,1] op_sel_hi:[1,0] neg_lo:[0,1]
  v_pk_fma_f32 v[98:99], v[98:99], v[82:83], v[100:101] op_sel:[0,0,0] op_sel_hi:[0,1,1]
  v_pk_fma_f32 v[122:123], v[122:123], v[106:107], v[124:125] op_sel:[0,0,0] op_sel_hi:[0,1,1]
  v_pk_fma_f32 v[96:97], v[84:85], v[94:95], v[102:103] op_sel:[0,0,0] op_sel_hi:[0,1,1]
  v_pk_fma_f32 v[120:121], v[108:109], v[118:119], v[126:127] op_sel:[0,0,0] op_sel_hi:[0,1,1]
  v_cvt_pk_bf16_f32 v134, v98, v99
  v_cvt_pk_bf16_f32 v135, v122, v123
  ds_write_b64 v81, v[134:135] offset:25872
  v_cvt_pk_bf16_f32 v136, v96, v97
  v_cvt_pk_bf16_f32 v137, v120, v121
  ds_write_b64 v81, v[136:137] offset:10032
  ds_write_b64 v81, v[136:137] offset:11616
  v_pk_mul_f32 v[100:101], v[98:99], v[82:83] op_sel:[1,1] op_sel_hi:[1,0] neg_lo:[0,1]
  v_pk_mul_f32 v[124:125], v[122:123], v[106:107] op_sel:[1,1] op_sel_hi:[1,0] neg_lo:[0,1]
  v_pk_mul_f32 v[102:103], v[96:97], v[94:95] op_sel:[1,1] op_sel_hi:[1,0] neg_lo:[0,1]
  v_pk_mul_f32 v[126:127], v[120:121], v[118:119] op_sel:[1,1] op_sel_hi:[1,0] neg_lo:[0,1]
  v_pk_fma_f32 v[98:99], v[98:99], v[82:83], v[100:101] op_sel:[0,0,0] op_sel_hi:[0,1,1]
  v_pk_fma_f32 v[122:123], v[122:123], v[106:107], v[124:125] op_sel:[0,0,0] op_sel_hi:[0,1,1]
  v_pk_fma_f32 v[96:97], v[96:97], v[94:95], v[102:103] op_sel:[0,0,0] op_sel_hi:[0,1,1]
  v_pk_fma_f32 v[120:121], v[120:121], v[118:119], v[126:127] op_sel:[0,0,0] op_sel_hi:[0,1,1]
  v_cvt_pk_bf16_f32 v130, v98, v99
  v_cvt_pk_bf16_f32 v131, v122, v123
  ds_write_b64 v81, v[130:131] offset:26400
  v_cvt_pk_bf16_f32 v132, v96, v97
  v_cvt_pk_bf16_f32 v133, v120, v121
  ds_write_b64 v81, v[132:133] offset:12144
  v_pk_mul_f32 v[100:101], v[98:99], v[82:83] op_sel:[1,1] op_sel_hi:[1,0] neg_lo:[0,1]
  v_pk_mul_f32 v[124:125], v[122:123], v[106:107] op_sel:[1,1] op_sel_hi:[1,0] neg_lo:[0,1]
  v_pk_mul_f32 v[102:103], v[84:85], v[90:91] op_sel:[1,1] op_sel_hi:[1,0] neg_lo:[0,1]
  v_pk_mul_f32 v[126:127], v[108:109], v[114:115] op_sel:[1,1] op_sel_hi:[1,0] neg_lo:[0,1]
  v_pk_fma_f32 v[98:99], v[98:99], v[82:83], v[100:101] op_sel:[0,0,0] op_sel_hi:[0,1,1]
  v_pk_fma_f32 v[122:123], v[122:123], v[106:107], v[124:125] op_sel:[0,0,0] op_sel_hi:[0,1,1]
  v_pk_fma_f32 v[84:85], v[84:85], v[90:91], v[102:103] op_sel:[0,0,0] op_sel_hi:[0,1,1]
  v_pk_fma_f32 v[108:109], v[108:109], v[114:115], v[126:127] op_sel:[0,0,0] op_sel_hi:[0,1,1]
  v_cvt_pk_bf16_f32 v134, v98, v99
  v_cvt_pk_bf16_f32 v135, v122, v123
  ds_write_b64 v81, v[134:135] offset:26928
  v_cvt_pk_bf16_f32 v136, v84, v85
  v_cvt_pk_bf16_f32 v137, v108, v109
  ds_write_b64 v81, v[136:137] offset:12672
  v_pk_mul_f32 v[100:101], v[98:99], v[82:83] op_sel:[1,1] op_sel_hi:[1,0] neg_lo:[0,1]
  v_pk_mul_f32 v[124:125], v[122:123], v[106:107] op_sel:[1,1] op_sel_hi:[1,0] neg_lo:[0,1]
  v_pk_mul_f32 v[102:103], v[84:85], v[88:89] op_sel:[1,1] op_sel_hi:[1,0] neg_lo:[0,1]
  v_pk_mul_f32 v[126:127], v[108:109], v[112:113] op_sel:[1,1] op_sel_hi:[1,0] neg_lo:[0,1]
  v_pk_fma_f32 v[98:99], v[98:99], v[82:83], v[100:101] op_sel:[0,0,0] op_sel_hi:[0,1,1]
  v_pk_fma_f32 v[122:123], v[122:123], v[106:107], v[124:125] op_sel:[0,0,0] op_sel_hi:[0,1,1]
  v_pk_fma_f32 v[96:97], v[84:85], v[88:89], v[102:103] op_sel:[0,0,0] op_sel_hi:[0,1,1]
  v_pk_fma_f32 v[120:121], v[108:109], v[112:113], v[126:127] op_sel:[0,0,0] op_sel_hi:[0,1,1]
  v_cvt_pk_bf16_f32 v130, v98, v99
  v_cvt_pk_bf16_f32 v131, v122, v123
  ds_write_b64 v81, v[130:131] offset:27456
  v_cvt_pk_bf16_f32 v132, v96, v97
  v_cvt_pk_bf16_f32 v133, v120, v121
  ds_write_b64 v81, v[132:133] offset:14784
  buffer_load_dword v207, v1, s[4:7], s78 offen  offset:896
  v_pk_mul_f32 v[100:101], v[98:99], v[82:83] op_sel:[1,1] op_sel_hi:[1,0] neg_lo:[0,1]
  v_pk_mul_f32 v[124:125], v[122:123], v[106:107] op_sel:[1,1] op_sel_hi:[1,0] neg_lo:[0,1]
  v_pk_mul_f32 v[102:103], v[84:85], v[90:91] op_sel:[1,1] op_sel_hi:[1,0] neg_lo:[0,1]
  v_pk_mul_f32 v[126:127], v[108:109], v[114:115] op_sel:[1,1] op_sel_hi:[1,0] neg_lo:[0,1]
  v_pk_fma_f32 v[98:99], v[98:99], v[82:83], v[100:101] op_sel:[0,0,0] op_sel_hi:[0,1,1]
  v_pk_fma_f32 v[122:123], v[122:123], v[106:107], v[124:125] op_sel:[0,0,0] op_sel_hi:[0,1,1]
  v_pk_fma_f32 v[84:85], v[84:85], v[90:91], v[102:103] op_sel:[0,0,0] op_sel_hi:[0,1,1]
  v_pk_fma_f32 v[108:109], v[108:109], v[114:115], v[126:127] op_sel:[0,0,0] op_sel_hi:[0,1,1]
  v_cvt_pk_bf16_f32 v134, v98, v99
  v_cvt_pk_bf16_f32 v135, v122, v123
  ds_write_b64 v81, v[134:135] offset:27984
  v_cvt_pk_bf16_f32 v136, v84, v85
  v_cvt_pk_bf16_f32 v137, v108, v109
  ds_write_b64 v81, v[136:137] offset:13200
  v_pk_mul_f32 v[100:101], v[98:99], v[82:83] op_sel:[1,1] op_sel_hi:[1,0] neg_lo:[0,1]
  v_pk_mul_f32 v[124:125], v[122:123], v[106:107] op_sel:[1,1] op_sel_hi:[1,0] neg_lo:[0,1]
  v_pk_mul_f32 v[102:103], v[84:85], v[88:89] op_sel:[1,1] op_sel_hi:[1,0] neg_lo:[0,1]
  v_pk_mul_f32 v[126:127], v[108:109], v[112:113] op_sel:[1,1] op_sel_hi:[1,0] neg_lo:[0,1]
  v_pk_fma_f32 v[98:99], v[98:99], v[82:83], v[100:101] op_sel:[0,0,0] op_sel_hi:[0,1,1]
  v_pk_fma_f32 v[122:123], v[122:123], v[106:107], v[124:125] op_sel:[0,0,0] op_sel_hi:[0,1,1]
  v_pk_fma_f32 v[96:97], v[84:85], v[88:89], v[102:103] op_sel:[0,0,0] op_sel_hi:[0,1,1]
  v_pk_fma_f32 v[120:121], v[108:109], v[112:113], v[126:127] op_sel:[0,0,0] op_sel_hi:[0,1,1]
  v_cvt_pk_bf16_f32 v130, v98, v99
  v_cvt_pk_bf16_f32 v131, v122, v123
  ds_write_b64 v81, v[130:131] offset:28512
  v_cvt_pk_bf16_f32 v132, v96, v97
  v_cvt_pk_bf16_f32 v133, v120, v121
  ds_write_b64 v81, v[132:133] offset:15312
  v_pk_mul_f32 v[100:101], v[98:99], v[82:83] op_sel:[1,1] op_sel_hi:[1,0] neg_lo:[0,1]
  v_pk_mul_f32 v[124:125], v[122:123], v[106:107] op_sel:[1,1] op_sel_hi:[1,0] neg_lo:[0,1]
  v_pk_mul_f32 v[102:103], v[84:85], v[90:91] op_sel:[1,1] op_sel_hi:[1,0] neg_lo:[0,1]
  v_pk_mul_f32 v[126:127], v[108:109], v[114:115] op_sel:[1,1] op_sel_hi:[1,0] neg_lo:[0,1]
  v_pk_fma_f32 v[98:99], v[98:99], v[82:83], v[100:101] op_sel:[0,0,0] op_sel_hi:[0,1,1]
  v_pk_fma_f32 v[122:123], v[122:123], v[106:107], v[124:125] op_sel:[0,0,0] op_sel_hi:[0,1,1]
  v_pk_fma_f32 v[84:85], v[84:85], v[90:91], v[102:103] op_sel:[0,0,0] op_sel_hi:[0,1,1]
  v_pk_fma_f32 v[108:109], v[108:109], v[114:115], v[126:127] op_sel:[0,0,0] op_sel_hi:[0,1,1]
  v_cvt_pk_bf16_f32 v134, v98, v99
  v_cvt_pk_bf16_f32 v135, v122, v123
  ds_write_b64 v81, v[134:135] offset:29040
  v_cvt_pk_bf16_f32 v136, v84, v85
  v_cvt_pk_bf16_f32 v137, v108, v109
  ds_write_b64 v81, v[136:137] offset:13728
  v_pk_mul_f32 v[100:101], v[98:99], v[82:83] op_sel:[1,1] op_sel_hi:[1,0] neg_lo:[0,1]
  v_pk_mul_f32 v[124:125], v[122:123], v[106:107] op_sel:[1,1] op_sel_hi:[1,0] neg_lo:[0,1]
  v_pk_mul_f32 v[102:103], v[84:85], v[88:89] op_sel:[1,1] op_sel_hi:[1,0] neg_lo:[0,1]
  v_pk_mul_f32 v[126:127], v[108:109], v[112:113] op_sel:[1,1] op_sel_hi:[1,0] neg_lo:[0,1]
  v_pk_fma_f32 v[98:99], v[98:99], v[82:83], v[100:101] op_sel:[0,0,0] op_sel_hi:[0,1,1]
  v_pk_fma_f32 v[122:123], v[122:123], v[106:107], v[124:125] op_sel:[0,0,0] op_sel_hi:[0,1,1]
  v_pk_fma_f32 v[96:97], v[84:85], v[88:89], v[102:103] op_sel:[0,0,0] op_sel_hi:[0,1,1]
  v_pk_fma_f32 v[120:121], v[108:109], v[112:113], v[126:127] op_sel:[0,0,0] op_sel_hi:[0,1,1]
  v_cvt_pk_bf16_f32 v130, v98, v99
  v_cvt_pk_bf16_f32 v131, v122, v123
  ds_write_b64 v81, v[130:131] offset:29568
  v_cvt_pk_bf16_f32 v132, v96, v97
  v_cvt_pk_bf16_f32 v133, v120, v121
  ds_write_b64 v81, v[132:133] offset:15840
  v_pk_mul_f32 v[100:101], v[98:99], v[82:83] op_sel:[1,1] op_sel_hi:[1,0] neg_lo:[0,1]
  v_pk_mul_f32 v[124:125], v[122:123], v[106:107] op_sel:[1,1] op_sel_hi:[1,0] neg_lo:[0,1]
  v_pk_mul_f32 v[102:103], v[84:85], v[90:91] op_sel:[1,1] op_sel_hi:[1,0] neg_lo:[0,1]
  v_pk_mul_f32 v[126:127], v[108:109], v[114:115] op_sel:[1,1] op_sel_hi:[1,0] neg_lo:[0,1]
  v_pk_fma_f32 v[98:99], v[98:99], v[82:83], v[100:101] op_sel:[0,0,0] op_sel_hi:[0,1,1]
  v_pk_fma_f32 v[122:123], v[122:123], v[106:107], v[124:125] op_sel:[0,0,0] op_sel_hi:[0,1,1]
  v_pk_fma_f32 v[84:85], v[84:85], v[90:91], v[102:103] op_sel:[0,0,0] op_sel_hi:[0,1,1]
  v_pk_fma_f32 v[108:109], v[108:109], v[114:115], v[126:127] op_sel:[0,0,0] op_sel_hi:[0,1,1]
  v_cvt_pk_bf16_f32 v134, v98, v99
  v_cvt_pk_bf16_f32 v135, v122, v123
  ds_write_b64 v81, v[134:135] offset:30096
  v_cvt_pk_bf16_f32 v136, v84, v85
  v_cvt_pk_bf16_f32 v137, v108, v109
  ds_write_b64 v81, v[136:137] offset:14256
  v_pk_mul_f32 v[100:101], v[98:99], v[82:83] op_sel:[1,1] op_sel_hi:[1,0] neg_lo:[0,1]
  v_pk_mul_f32 v[124:125], v[122:123], v[106:107] op_sel:[1,1] op_sel_hi:[1,0] neg_lo:[0,1]
  v_pk_mul_f32 v[102:103], v[84:85], v[88:89] op_sel:[1,1] op_sel_hi:[1,0] neg_lo:[0,1]
  v_pk_mul_f32 v[126:127], v[108:109], v[112:113] op_sel:[1,1] op_sel_hi:[1,0] neg_lo:[0,1]
  v_pk_fma_f32 v[98:99], v[98:99], v[82:83], v[100:101] op_sel:[0,0,0] op_sel_hi:[0,1,1]
  v_pk_fma_f32 v[122:123], v[122:123], v[106:107], v[124:125] op_sel:[0,0,0] op_sel_hi:[0,1,1]
  v_pk_fma_f32 v[96:97], v[84:85], v[88:89], v[102:103] op_sel:[0,0,0] op_sel_hi:[0,1,1]
  v_pk_fma_f32 v[120:121], v[108:109], v[112:113], v[126:127] op_sel:[0,0,0] op_sel_hi:[0,1,1]
  v_cvt_pk_bf16_f32 v130, v98, v99
  v_cvt_pk_bf16_f32 v131, v122, v123
  ds_write_b64 v81, v[130:131] offset:30624
  v_cvt_pk_bf16_f32 v132, v96, v97
  v_cvt_pk_bf16_f32 v133, v120, v121
  ds_write_b64 v81, v[132:133] offset:16368
  v_pk_mul_f32 v[100:101], v[98:99], v[82:83] op_sel:[1,1] op_sel_hi:[1,0] neg_lo:[0,1]
  v_pk_mul_f32 v[124:125], v[122:123], v[106:107] op_sel:[1,1] op_sel_hi:[1,0] neg_lo:[0,1]
  v_pk_fma_f32 v[98:99], v[98:99], v[82:83], v[100:101] op_sel:[0,0,0] op_sel_hi:[0,1,1]
  v_pk_fma_f32 v[122:123], v[122:123], v[106:107], v[124:125] op_sel:[0,0,0] op_sel_hi:[0,1,1]
  v_cvt_pk_bf16_f32 v134, v98, v99
  v_cvt_pk_bf16_f32 v135, v122, v123
  ds_write_b64 v81, v[134:135] offset:31152
  v_pk_mul_f32 v[100:101], v[98:99], v[82:83] op_sel:[1,1] op_sel_hi:[1,0] neg_lo:[0,1]
  v_pk_mul_f32 v[124:125], v[122:123], v[106:107] op_sel:[1,1] op_sel_hi:[1,0] neg_lo:[0,1]
  v_pk_fma_f32 v[98:99], v[98:99], v[82:83], v[100:101] op_sel:[0,0,0] op_sel_hi:[0,1,1]
  v_pk_fma_f32 v[122:123], v[122:123], v[106:107], v[124:125] op_sel:[0,0,0] op_sel_hi:[0,1,1]
  v_cvt_pk_bf16_f32 v136, v98, v99
  v_cvt_pk_bf16_f32 v137, v122, v123
  ds_write_b64 v81, v[136:137] offset:31680
  v_pk_mul_f32 v[100:101], v[98:99], v[82:83] op_sel:[1,1] op_sel_hi:[1,0] neg_lo:[0,1]
  v_pk_mul_f32 v[124:125], v[122:123], v[106:107] op_sel:[1,1] op_sel_hi:[1,0] neg_lo:[0,1]
  v_pk_fma_f32 v[98:99], v[98:99], v[82:83], v[100:101] op_sel:[0,0,0] op_sel_hi:[0,1,1]
  v_pk_fma_f32 v[122:123], v[122:123], v[106:107], v[124:125] op_sel:[0,0,0] op_sel_hi:[0,1,1]
  v_cvt_pk_bf16_f32 v130, v98, v99
  v_cvt_pk_bf16_f32 v131, v122, v123
  ds_write_b64 v81, v[130:131] offset:32208
  v_pk_mul_f32 v[100:101], v[98:99], v[82:83] op_sel:[1,1] op_sel_hi:[1,0] neg_lo:[0,1]
  v_pk_mul_f32 v[124:125], v[122:123], v[106:107] op_sel:[1,1] op_sel_hi:[1,0] neg_lo:[0,1]
  v_pk_fma_f32 v[98:99], v[98:99], v[82:83], v[100:101] op_sel:[0,0,0] op_sel_hi:[0,1,1]
  v_pk_fma_f32 v[122:123], v[122:123], v[106:107], v[124:125] op_sel:[0,0,0] op_sel_hi:[0,1,1]
  v_cvt_pk_bf16_f32 v132, v98, v99
  v_cvt_pk_bf16_f32 v133, v122, v123
  ds_write_b64 v81, v[132:133] offset:32736
  v_pk_mul_f32 v[100:101], v[98:99], v[82:83] op_sel:[1,1] op_sel_hi:[1,0] neg_lo:[0,1]
  v_pk_mul_f32 v[124:125], v[122:123], v[106:107] op_sel:[1,1] op_sel_hi:[1,0] neg_lo:[0,1]
  v_pk_fma_f32 v[98:99], v[98:99], v[82:83], v[100:101] op_sel:[0,0,0] op_sel_hi:[0,1,1]
  v_pk_fma_f32 v[122:123], v[122:123], v[106:107], v[124:125] op_sel:[0,0,0] op_sel_hi:[0,1,1]
  v_cvt_pk_bf16_f32 v134, v98, v99
  v_cvt_pk_bf16_f32 v135, v122, v123
  ds_write_b64 v81, v[134:135] offset:33264
  v_and_b32 v142, 31, v0
  v_mul_u32_u24 v142, 528, v142
  v_bfe_u32 v143, v0, 5, 1
  v_lshl_add_u32 v142, v143, 4, v142
  v_add_u32 v142, s80, v142
  v_add_u32 v143, 16896, v142
  s_waitcnt lgkmcnt(0)
  ds_read_b128 v[160:163], v142 offset:0
  ds_read_b128 v[176:179], v143 offset:0
  ds_read_b128 v[164:167], v142 offset:32
  ds_read_b128 v[180:183], v143 offset:32
  ds_read_b128 v[168:171], v142 offset:64
  ds_read_b128 v[184:187], v143 offset:64
  ds_read_b128 v[172:175], v142 offset:96
  ds_read_b128 v[188:191], v143 offset:96
  s_waitcnt lgkmcnt(6)
  v_mfma_f32_32x32x16_bf16 v[144:159], v[160:163], v[176:179], 0
  ds_read_b128 v[160:163], v142 offset:128
  ds_read_b128 v[176:179], v143 offset:128
  s_waitcnt lgkmcnt(6)
  v_mfma_f32_32x32x16_bf16 v[144:159], v[164:167], v[180:183], v[144:159]
  ds_read_b128 v[164:167], v142 offset:160
  ds_read_b128 v[180:183], v143 offset:160
  s_waitcnt lgkmcnt(6)
  v_mfma_f32_32x32x16_bf16 v[144:159], v[168:171], v[184:187], v[144:159]
  ds_read_b128 v[168:171], v142 offset:192
  ds_read_b128 v[184:187], v143 offset:192
  s_waitcnt lgkmcnt(6)
  v_mfma_f32_32x32x16_bf16 v[144:159], v[172:175], v[188:191], v[144:159]
  ds_read_b128 v[172:175], v142 offset:224
  ds_read_b128 v[188:191], v143 offset:224
  s_waitcnt lgkmcnt(6)
  v_mfma_f32_32x32x16_bf16 v[144:159], v[160:163], v[176:179], v[144:159]
  ds_read_b128 v[160:163], v142 offset:256
  ds_read_b128 v[176:179], v143 offset:256
  s_waitcnt lgkmcnt(6)
  v_mfma_f32_32x32x16_bf16 v[144:159], v[164:167], v[180:183], v[144:159]
  ds_read_b128 v[164:167], v142 offset:288
  ds_read_b128 v[180:183], v143 offset:288
  s_waitcnt lgkmcnt(6)
  v_mfma_f32_32x32x16_bf16 v[144:159], v[168:171], v[184:187], v[144:159]
  ds_read_b128 v[168:171], v142 offset:320
  ds_read_b128 v[184:187], v143 offset:320
  s_waitcnt lgkmcnt(6)
  v_mfma_f32_32x32x16_bf16 v[144:159], v[172:175], v[188:191], v[144:159]
  ds_read_b128 v[172:175], v142 offset:352
  ds_read_b128 v[188:191], v143 offset:352
  s_waitcnt lgkmcnt(6)
  v_mfma_f32_32x32x16_bf16 v[144:159], v[160:163], v[176:179], v[144:159]
  ds_read_b128 v[160:163], v142 offset:384
  ds_read_b128 v[176:179], v143 offset:384
  s_waitcnt lgkmcnt(6)
  v_mfma_f32_32x32x16_bf16 v[144:159], v[164:167], v[180:183], v[144:159]
  ds_read_b128 v[164:167], v142 offset:416
  ds_read_b128 v[180:183], v143 offset:416
  s_waitcnt lgkmcnt(6)
  v_mfma_f32_32x32x16_bf16 v[144:159], v[168:171], v[184:187], v[144:159]
  ds_read_b128 v[168:171], v142 offset:448
  ds_read_b128 v[184:187], v143 offset:448
  s_waitcnt lgkmcnt(6)
  v_mfma_f32_32x32x16_bf16 v[144:159], v[172:175], v[188:191], v[144:159]
  ds_read_b128 v[172:175], v142 offset:480
  ds_read_b128 v[188:191], v143 offset:480
  s_waitcnt lgkmcnt(6)
  v_mfma_f32_32x32x16_bf16 v[144:159], v[160:163], v[176:179], v[144:159]
  s_waitcnt lgkmcnt(4)
  v_mfma_f32_32x32x16_bf16 v[144:159], v[164:167], v[180:183], v[144:159]
  s_waitcnt lgkmcnt(2)
  v_mfma_f32_32x32x16_bf16 v[144:159], v[168:171], v[184:187], v[144:159]
  s_waitcnt lgkmcnt(0)
  v_mfma_f32_32x32x16_bf16 v[144:159], v[172:175], v[188:191], v[144:159]
  v_lshrrev_b32 v2, 6, v0
  v_lshlrev_b32 v2, 8, v2
  v_and_b32 v208, 63, v0
  v_add_u32 v2, v2, v208
  v_lshlrev_b32 v2, 4, v2
  s_mov_b32 s79, 15728640
  buffer_load_dwordx4 v[208:211], v2, s[8:11], s79 offen offset:0 sc1
  buffer_load_dwordx4 v[212:215], v2, s[8:11], s79 offen offset:1024 sc1
  buffer_load_dwordx4 v[216:219], v2, s[8:11], s79 offen offset:2048 sc1
  buffer_load_dwordx4 v[220:223], v2, s[8:11], s79 offen offset:3072 sc1
  s_barrier
  s_and_b32 s81, s28, 1
  s_cmp_eq_u32 s81, 0
  s_nop 7
  s_nop 1
  s_cbranch_scc1 KG_keep_lo
  v_mov_b32 v160, v144
  v_mov_b32 v144, v152
  v_mov_b32 v161, v145
  v_mov_b32 v145, v153
  v_mov_b32 v162, v146
  v_mov_b32 v146, v154
  v_mov_b32 v163, v147
  v_mov_b32 v147, v155
  v_mov_b32 v164, v148
  v_mov_b32 v148, v156
  v_mov_b32 v165, v149
  v_mov_b32 v149, v157
  v_mov_b32 v166, v150
  v_mov_b32 v150, v158
  v_mov_b32 v167, v151
  v_mov_b32 v151, v159
  s_branch KG_sel_done
KG_keep_lo:
  v_mov_b32 v160, v152
  v_mov_b32 v161, v153
  v_mov_b32 v162, v154
  v_mov_b32 v163, v155
  v_mov_b32 v164, v156
  v_mov_b32 v165, v157
  v_mov_b32 v166, v158
  v_mov_b32 v167, v159
KG_sel_done:
  v_and_b32 v142, 63, v0
  v_lshlrev_b32 v142, 4, v142
  s_lshl_b32 s80, s28, 11
  s_add_u32 s80, s80, 93312
  v_add_u32 v143, s80, v142
  s_xor_b32 s82, s28, 1
  s_lshl_b32 s82, s82, 11
  s_add_u32 s80, s82, 93312
  v_add_u32 v142, s80, v142
  ds_write_b128 v142, v[160:163]
  ds_write_b128 v142, v[164:167] offset:1024
  v_mov_b32 v176, 0
  v_mov_b32 v177, 0
  v_mov_b32 v178, 0
  v_mov_b32 v179, 0
  v_and_b32 v180, 15, v0
  v_lshrrev_b32 v181, 3, v180
  v_and_b32 v182, 7, v180
  v_mul_u32_u24 v181, 33280, v181
  v_mul_u32_u24 v182, 4160, v182
  v_add3_u32 v181, v181, v182, 0
  v_add_u32 v181, 22528, v181
  v_and_b32 v180, 3, v0
  v_lshrrev_b32 v182, 1, v180
  v_mul_u32_u24 v182, 4160, v182
  v_and_b32 v180, 1, v0
  v_lshl_add_u32 v182, v180, 4, v182
  v_add_u32 v182, 89088, v182
  ds_write_b128 v181, v[176:179]
  ds_write_b128 v182, v[176:179]
  s_waitcnt lgkmcnt(0)
  s_barrier
  ds_read_b128 v[160:163], v143
  ds_read_b128 v[164:167], v143 offset:1024
  v_and_b32 v142, 31, v0
  v_bfe_u32 v143, v0, 5, 1
  v_lshlrev_b32 v180, 4, v142
  v_lshl_add_u32 v180, v143, 3, v180
  s_lshr_b32 s80, s28, 1
  s_mul_i32 s80, s80, 4160
  s_add_u32 s80, s80, 85496
  v_sub_u32 v180, s80, v180
  v_and_b32 v142, 1, v142
  v_xor_b32 v142, 1, v142
  v_and_b32 v142, v142, v143
  v_cmp_eq_u32 s[86:87], 1, v142
  v_cmp_eq_u32 vcc, 1, v143
  s_waitcnt lgkmcnt(0)
  v_pk_add_f32 v[144:145], v[144:145], v[160:161]
  v_pk_add_f32 v[146:147], v[146:147], v[162:163]
  v_pk_add_f32 v[148:149], v[148:149], v[164:165]
  v_pk_add_f32 v[150:151], v[150:151], v[166:167]
  s_cmp_eq_u32 s81, 0
  s_cbranch_scc0 KG_exp_hi
  v_cvt_pk_bf16_f32 v160, v147, v146
  v_cvt_pk_bf16_f32 v161, v145, v144
  v_cvt_pk_bf16_f32 v162, v150, v149
  v_cvt_pk_bf16_f32 v163, v148, v148
  ds_write_b64 v180, v[160:161] offset:3584
  ds_write_b64 v180, v[162:163] offset:3072
  s_branch KG_exp_done
KG_exp_hi:
  v_cndmask_b32 v152, v144, v145, vcc
  v_cvt_pk_bf16_f32 v160, v145, v152
  v_cvt_pk_bf16_f32 v161, v144, v144
  ds_write_b64 v180, v[160:161] offset:2560
  v_cndmask_b32 v152, v146, v147, vcc
  v_cvt_pk_bf16_f32 v162, v147, v152
  v_cvt_pk_bf16_f32 v163, v146, v146
  ds_write_b64 v180, v[162:163] offset:2048
  v_mov_b32 v152, v148
  v_mov_b32 v156, v148
  v_mov_b32 v153, v149
  v_mov_b32 v157, v149
  v_mov_b32 v154, v150
  v_mov_b32 v158, v150
  v_mov_b32 v155, v151
  v_mov_b32 v159, v151
  v_permlane32_swap_b32 v152, v156
  v_permlane32_swap_b32 v153, v157
  v_permlane32_swap_b32 v154, v158
  v_permlane32_swap_b32 v155, v159
  v_cndmask_b32 v152, v148, v152, s[86:87]
  v_cvt_pk_bf16_f32 v164, v148, v148
  v_cvt_pk_bf16_f32 v165, v148, v152
  ds_write_b64 v180, v[164:165] offset:1536
  v_cndmask_b32 v153, v149, v153, s[86:87]
  v_cvt_pk_bf16_f32 v166, v149, v149
  v_cvt_pk_bf16_f32 v167, v149, v153
  ds_write_b64 v180, v[166:167] offset:1024
  v_cndmask_b32 v154, v150, v154, s[86:87]
  v_cvt_pk_bf16_f32 v168, v150, v150
  v_cvt_pk_bf16_f32 v169, v150, v154
  ds_write_b64 v180, v[168:169] offset:512
  v_cndmask_b32 v155, v151, v155, s[86:87]
  v_cvt_pk_bf16_f32 v170, v151, v151
  v_cvt_pk_bf16_f32 v171, v151, v155
  ds_write_b64 v180, v[170:171] offset:0
KG_exp_done:
  s_waitcnt vmcnt(0)
  s_mov_b32 s88, 0
RC_loop:
  v_cmp_ne_u32 s[82:83], s29, v210
  v_cmp_ne_u32 vcc, s29, v214
  s_or_b64 s[82:83], s[82:83], vcc
  v_cmp_ne_u32 vcc, s29, v218
  s_or_b64 s[82:83], s[82:83], vcc
  v_cmp_ne_u32 vcc, s29, v222
  s_or_b64 s[82:83], s[82:83], vcc
  s_cmp_eq_u64 s[82:83], 0
  s_cbranch_scc1 RC_done
  s_add_u32 s88, s88, 1
  s_cmp_ge_u32 s88, 200000
  s_cbranch_scc1 RC_done
  v_lshrrev_b32 v1, 6, v0
  v_lshlrev_b32 v1, 8, v1
  v_and_b32 v208, 63, v0
  v_add_u32 v1, v1, v208
  v_lshlrev_b32 v1, 4, v1
  s_mov_b32 s79, 15728640
  buffer_load_dwordx4 v[208:211], v1, s[8:11], s79 offen offset:0 sc1
  buffer_load_dwordx4 v[212:215], v1, s[8:11], s79 offen offset:1024 sc1
  buffer_load_dwordx4 v[216:219], v1, s[8:11], s79 offen offset:2048 sc1
  buffer_load_dwordx4 v[220:223], v1, s[8:11], s79 offen offset:3072 sc1
  s_waitcnt vmcnt(0)
  s_branch RC_loop
RC_done:
  buffer_load_dword v251, v250, s[20:23], 0 offen
  s_mov_b32 s84, 0x05040100
  s_mov_b32 s85, 0x07060302
  v_lshrrev_b32 v211, 6, v0
  v_lshlrev_b32 v211, 12, v211
  v_and_b32 v8, 63, v0
  v_lshl_add_u32 v211, v8, 2, v211
  v_add_u32 v211, 2048, v211
  v_lshlrev_b32 v8, 16, v200
  v_and_b32 v9, s91, v200
  v_lshlrev_b32 v12, 16, v208
  v_and_b32 v13, s91, v208
  v_lshlrev_b32 v10, 16, v201
  v_and_b32 v11, s91, v201
  v_lshlrev_b32 v14, 16, v209
  v_and_b32 v15, s91, v209
  v_rcp_f32 v13, v13
  v_rcp_f32 v15, v15
  v_pk_add_f32 v[8:9], v[8:9], v[12:13] op_sel_hi:[1,0] neg_lo:[0,1] neg_hi:[0,1]
  v_pk_add_f32 v[10:11], v[10:11], v[14:15] op_sel_hi:[1,0] neg_lo:[0,1] neg_hi:[0,1]
  v_perm_b32 v28, v201, v200, s84
  v_cvt_pk_bf16_f32 v16, v8, v9
  v_cvt_pk_bf16_f32 v17, v10, v11
  v_perm_b32 v32, v201, v200, s85
  v_lshlrev_b32 v8, 16, v16
  v_and_b32 v9, s91, v16
  v_lshlrev_b32 v10, 16, v17
  v_and_b32 v11, s91, v17
  v_pk_mul_f32 v[8:9], v[8:9], v[12:13] op_sel:[0,1] op_sel_hi:[1,1]
  v_pk_mul_f32 v[10:11], v[10:11], v[14:15] op_sel:[0,1] op_sel_hi:[1,1]
  v_cvt_pk_bf16_f32 v20, v8, v10
  v_cvt_pk_bf16_f32 v24, v9, v11
  ds_write2st64_b32 v211, v28, v32 offset0:2 offset1:3
  ds_write2st64_b32 v211, v20, v24 offset0:0 offset1:1
  v_lshlrev_b32 v8, 16, v202
  v_and_b32 v9, s91, v202
  v_lshlrev_b32 v12, 16, v212
  v_and_b32 v13, s91, v212
  v_lshlrev_b32 v10, 16, v203
  v_and_b32 v11, s91, v203
  v_lshlrev_b32 v14, 16, v213
  v_and_b32 v15, s91, v213
  v_rcp_f32 v13, v13
  v_rcp_f32 v15, v15
  v_pk_add_f32 v[8:9], v[8:9], v[12:13] op_sel_hi:[1,0] neg_lo:[0,1] neg_hi:[0,1]
  v_pk_add_f32 v[10:11], v[10:11], v[14:15] op_sel_hi:[1,0] neg_lo:[0,1] neg_hi:[0,1]
  v_perm_b32 v29, v203, v202, s84
  v_cvt_pk_bf16_f32 v16, v8, v9
  v_cvt_pk_bf16_f32 v17, v10, v11
  v_perm_b32 v33, v203, v202, s85
  v_lshlrev_b32 v8, 16, v16
  v_and_b32 v9, s91, v16
  v_lshlrev_b32 v10, 16, v17
  v_and_b32 v11, s91, v17
  v_pk_mul_f32 v[8:9], v[8:9], v[12:13] op_sel:[0,1] op_sel_hi:[1,1]
  v_pk_mul_f32 v[10:11], v[10:11], v[14:15] op_sel:[0,1] op_sel_hi:[1,1]
  v_cvt_pk_bf16_f32 v21, v8, v10
  v_cvt_pk_bf16_f32 v25, v9, v11
  ds_write2st64_b32 v211, v29, v33 offset0:6 offset1:7
  ds_write2st64_b32 v211, v21, v25 offset0:4 offset1:5
  v_lshlrev_b32 v8, 16, v204
  v_and_b32 v9, s91, v204
  v_lshlrev_b32 v12, 16, v216
  v_and_b32 v13, s91, v216
  v_lshlrev_b32 v10, 16, v205
  v_and_b32 v11, s91, v205
  v_lshlrev_b32 v14, 16, v217
  v_and_b32 v15, s91, v217
  v_rcp_f32 v13, v13
  v_rcp_f32 v15, v15
  v_pk_add_f32 v[8:9], v[8:9], v[12:13] op_sel_hi:[1,0] neg_lo:[0,1] neg_hi:[0,1]
  v_pk_add_f32 v[10:11], v[10:11], v[14:15] op_sel_hi:[1,0] neg_lo:[0,1] neg_hi:[0,1]
  v_perm_b32 v30, v205, v204, s84
  v_cvt_pk_bf16_f32 v16, v8, v9
  v_cvt_pk_bf16_f32 v17, v10, v11
  v_perm_b32 v34, v205, v204, s85
  v_lshlrev_b32 v8, 16, v16
  v_and_b32 v9, s91, v16
  v_lshlrev_b32 v10, 16, v17
  v_and_b32 v11, s91, v17
  v_pk_mul_f32 v[8:9], v[8:9], v[12:13] op_sel:[0,1] op_sel_hi:[1,1]
  v_pk_mul_f32 v[10:11], v[10:11], v[14:15] op_sel:[0,1] op_sel_hi:[1,1]
  v_cvt_pk_bf16_f32 v22, v8, v10
  v_cvt_pk_bf16_f32 v26, v9, v11
  ds_write2st64_b32 v211, v30, v34 offset0:10 offset1:11
  ds_write2st64_b32 v211, v22, v26 offset0:8 offset1:9
  v_lshlrev_b32 v8, 16, v206
  v_and_b32 v9, s91, v206
  v_lshlrev_b32 v12, 16, v220
  v_and_b32 v13, s91, v220
  v_lshlrev_b32 v10, 16, v207
  v_and_b32 v11, s91, v207
  v_lshlrev_b32 v14, 16, v221
  v_and_b32 v15, s91, v221
  v_rcp_f32 v13, v13
  v_rcp_f32 v15, v15
  v_pk_add_f32 v[8:9], v[8:9], v[12:13] op_sel_hi:[1,0] neg_lo:[0,1] neg_hi:[0,1]
  v_pk_add_f32 v[10:11], v[10:11], v[14:15] op_sel_hi:[1,0] neg_lo:[0,1] neg_hi:[0,1]
  v_perm_b32 v31, v207, v206, s84
  v_cvt_pk_bf16_f32 v16, v8, v9
  v_cvt_pk_bf16_f32 v17, v10, v11
  v_perm_b32 v35, v207, v206, s85
  v_lshlrev_b32 v8, 16, v16
  v_and_b32 v9, s91, v16
  v_lshlrev_b32 v10, 16, v17
  v_and_b32 v11, s91, v17
  v_pk_mul_f32 v[8:9], v[8:9], v[12:13] op_sel:[0,1] op_sel_hi:[1,1]
  v_pk_mul_f32 v[10:11], v[10:11], v[14:15] op_sel:[0,1] op_sel_hi:[1,1]
  v_cvt_pk_bf16_f32 v23, v8, v10
  v_cvt_pk_bf16_f32 v27, v9, v11
  ds_write2st64_b32 v211, v31, v35 offset0:14 offset1:15
  ds_write2st64_b32 v211, v23, v27 offset0:12 offset1:13
  v_and_b32 v142, 63, v0
  s_lshl_b32 s81, s81, 7
  v_add_u32 v142, s81, v142
  v_lshlrev_b32 v142, 4, v142
  s_lshr_b32 s80, s28, 1
  s_mul_i32 s81, s80, 4160
  s_add_u32 s81, s81, 84992
  v_add_u32 v143, s81, v142
  s_mul_i32 s81, s80, 33280
  s_add_u32 s81, s81, 18432
  v_add_u32 v142, s81, v142
  s_waitcnt lgkmcnt(0)
  s_barrier
  ds_read_b128 v[82:85], v143 offset:0
  ds_read_b128 v[86:89], v143 offset:16
  ds_read_b128 v[114:117], v143 offset:1024
  ds_read_b128 v[118:121], v143 offset:1040
  s_waitcnt lgkmcnt(2)
  ds_write_b128 v142, v[82:85] offset:29120
  ds_write_b128 v142, v[84:87] offset:12480
  v_pk_mov_b32 v[90:91], v[82:83], v[84:85] op_sel:[1,0]
  v_pk_mov_b32 v[92:93], v[84:85], v[86:87] op_sel:[1,0]
  v_pk_mov_b32 v[94:95], v[86:87], v[88:89] op_sel:[1,0]
  ds_write_b128 v142, v[90:93] offset:20800
  ds_write_b128 v142, v[92:95] offset:4160
  v_alignbit_b32 v96, v83, v82, 16
  v_alignbit_b32 v97, v84, v83, 16
  v_alignbit_b32 v98, v85, v84, 16
  v_alignbit_b32 v99, v86, v85, 16
  v_alignbit_b32 v100, v87, v86, 16
  v_alignbit_b32 v101, v88, v87, 16
  ds_write_b128 v142, v[96:99] offset:24960
  ds_write_b128 v142, v[98:101] offset:8320
  v_alignbit_b32 v104, v84, v83, 16
  v_alignbit_b32 v105, v85, v84, 16
  v_alignbit_b32 v106, v86, v85, 16
  v_alignbit_b32 v107, v87, v86, 16
  v_alignbit_b32 v108, v88, v87, 16
  v_alignbit_b32 v109, v89, v88, 16
  ds_write_b128 v142, v[104:107] offset:16640
  ds_write_b128 v142, v[106:109] offset:0
  s_waitcnt lgkmcnt(8)
  ds_write_b128 v142, v[114:117] offset:30144
  ds_write_b128 v142, v[116:119] offset:13504
  v_pk_mov_b32 v[122:123], v[114:115], v[116:117] op_sel:[1,0]
  v_pk_mov_b32 v[124:125], v[116:117], v[118:119] op_sel:[1,0]
  v_pk_mov_b32 v[126:127], v[118:119], v[120:121] op_sel:[1,0]
  ds_write_b128 v142, v[122:125] offset:21824
  ds_write_b128 v142, v[124:127] offset:5184
  v_alignbit_b32 v128, v115, v114, 16
  v_alignbit_b32 v129, v116, v115, 16
  v_alignbit_b32 v130, v117, v116, 16
  v_alignbit_b32 v131, v118, v117, 16
  v_alignbit_b32 v132, v119, v118, 16
  v_alignbit_b32 v133, v120, v119, 16
  ds_write_b128 v142, v[128:131] offset:25984
  ds_write_b128 v142, v[130:133] offset:9344
  v_alignbit_b32 v136, v116, v115, 16
  v_alignbit_b32 v137, v117, v116, 16
  v_alignbit_b32 v138, v118, v117, 16
  v_alignbit_b32 v139, v119, v118, 16
  v_alignbit_b32 v140, v120, v119, 16
  v_alignbit_b32 v141, v121, v120, 16
  ds_write_b128 v142, v[136:139] offset:17664
  ds_write_b128 v142, v[138:141] offset:1024
  s_waitcnt lgkmcnt(0)
  s_barrier
  s_or_b32 s80, s2, s28
  s_cmp_lg_u32 s80, 0
  s_cbranch_scc1 EP_skip
  s_mov_b32 s80, 15859712
  v_mov_b32 v1, 0
  v_mov_b32 v2, s29
  s_mov_b64 exec, 1
  buffer_store_dword v2, v1, s[8:11], s80 offen sc1
  s_mov_b64 exec, -1
EP_skip:
  v_and_b32 v1, 15, v0
  v_bfe_u32 v2, v0, 4, 2
  s_lshr_b32 s80, s28, 1
  s_and_b32 s81, s28, 1
  v_and_b32 v3, 7, v1
  v_mul_u32_u24 v3, 4160, v3
  v_lshl_add_u32 v3, v2, 4, v3
  v_and_b32 v4, 8, v1
  v_lshlrev_b32 v4, 1, v4
  v_sub_u32 v3, v3, v4
  s_mul_i32 s82, s80, 33280
  s_lshl_b32 s83, s81, 8
  s_sub_u32 s82, s82, s83
  s_add_u32 s82, s82, 18704
  v_add_u32 v3, s82, v3
  v_lshl_add_u32 v4, v1, 1, v2
  v_add_u32 v4, 30, v4
  s_lshl_b32 s83, s81, 4
  v_subrev_u32 v4, s83, v4
  s_lshl_b32 s82, s80, 8
  s_add_u32 s82, s82, 0
  v_subrev_u32 v5, 0, v4
  v_and_b32 v6, 15, v5
  v_lshrrev_b32 v5, 4, v5
  v_lshlrev_b32 v5, 10, v5
  v_lshl_add_u32 v5, v6, 4, v5
  v_add_u32 v232, s82, v5
  v_subrev_u32 v5, 4, v4
  v_and_b32 v6, 15, v5
  v_lshrrev_b32 v5, 4, v5
  v_lshlrev_b32 v5, 10, v5
  v_lshl_add_u32 v5, v6, 4, v5
  v_add_u32 v233, s82, v5
  v_subrev_u32 v5, 8, v4
  v_and_b32 v6, 15, v5
  v_lshrrev_b32 v5, 4, v5
  v_lshlrev_b32 v5, 10, v5
  v_lshl_add_u32 v5, v6, 4, v5
  v_add_u32 v234, s82, v5
  v_subrev_u32 v5, 12, v4
  v_and_b32 v6, 15, v5
  v_lshrrev_b32 v5, 4, v5
  v_lshlrev_b32 v5, 10, v5
  v_lshl_add_u32 v5, v6, 4, v5
  v_add_u32 v235, s82, v5
  ds_read_b128 v[40:43], v3 offset:3776
  ds_read_b128 v[104:107], v232 offset:0
  ds_read_b128 v[44:47], v3 offset:3264
  ds_read_b128 v[108:111], v232 offset:2048
  ds_read_b128 v[48:51], v3 offset:2752
  ds_read_b128 v[112:115], v232 offset:4096
  ds_read_b128 v[52:55], v3 offset:2240
  ds_read_b128 v[116:119], v232 offset:6144
  ds_read_b128 v[56:59], v3 offset:1728
  ds_read_b128 v[120:123], v232 offset:8192
  ds_read_b128 v[60:63], v3 offset:1216
  ds_read_b128 v[124:127], v232 offset:10240
  ds_read_b128 v[64:67], v3 offset:704
  ds_read_b128 v[128:131], v232 offset:12288
  ds_read_b128 v[68:71], v3 offset:192
  ds_read_b128 v[132:135], v232 offset:14336
  v_and_b32 v5, 63, v0
  v_lshlrev_b32 v5, 4, v5
  s_xor_b32 s82, s28, 1
  s_lshl_b32 s82, s82, 12
  s_add_u32 s82, s82, 98304
  v_add_u32 v6, s82, v5
  s_lshl_b32 s82, s28, 12
  s_add_u32 s82, s82, 98304
  v_add_u32 v5, s82, v5
  v_lshrrev_b32 v4, 3, v1
  v_lshlrev_b32 v4, 10, v4
  v_and_b32 v7, 7, v1
  v_lshl_add_u32 v4, v7, 5, v4
  v_lshl_add_u32 v4, v2, 3, v4
  s_lshl_b32 s82, s81, 13
  s_lshl_b32 s83, s80, 8
  s_add_u32 s82, s82, s83
  s_add_u32 s82, s82, 2048
  v_add_u32 v4, s82, v4
  v_lshrrev_b32 v226, 3, v1
  s_mov_b32 s82, 114688
  v_mul_lo_u32 v226, v226, s82
  v_lshl_add_u32 v226, v2, 3, v226
  v_lshl_add_u32 v226, v7, 5, v226
  s_lshl_b32 s82, s30, 1
  s_add_u32 s82, s82, s80
  s_lshl_b32 s82, s82, 8
  s_mul_i32 s83, s81, 917504
  s_add_u32 s82, s82, s83
  s_lshl_b32 s83, s80, 4
  s_lshr_b32 s83, s33, s83
  s_lshl_b32 s84, s83, 16
  s_mov_b32 s85, s84
  s_waitcnt lgkmcnt(14)
  v_mfma_f32_16x16x32_bf16 v[8:11], v[40:43], v[104:107], 0
  s_waitcnt lgkmcnt(12)
  v_mfma_f32_16x16x32_bf16 v[12:15], v[40:43], v[108:111], 0
  v_mfma_f32_16x16x32_bf16 v[12:15], v[44:47], v[104:107], v[12:15]
  v_mfma_f32_16x16x32_bf16 v[16:19], v[44:47], v[108:111], 0
  s_waitcnt lgkmcnt(10)
  v_mfma_f32_16x16x32_bf16 v[16:19], v[40:43], v[112:115], v[16:19]
  v_mfma_f32_16x16x32_bf16 v[20:23], v[44:47], v[112:115], 0
  v_mfma_f32_16x16x32_bf16 v[16:19], v[48:51], v[104:107], v[16:19]
  v_mfma_f32_16x16x32_bf16 v[20:23], v[48:51], v[108:111], v[20:23]
  v_mfma_f32_16x16x32_bf16 v[24:27], v[48:51], v[112:115], 0
  ds_read_b128 v[72:75], v3 offset:3712
  s_waitcnt lgkmcnt(9)
  v_mfma_f32_16x16x32_bf16 v[20:23], v[40:43], v[116:119], v[20:23]
  ds_read_b128 v[136:139], v233 offset:0
  v_mfma_f32_16x16x32_bf16 v[24:27], v[44:47], v[116:119], v[24:27]
  ds_read_b128 v[76:79], v3 offset:3200
  v_mfma_f32_16x16x32_bf16 v[28:31], v[48:51], v[116:119], 0
  ds_read_b128 v[140:143], v233 offset:2048
  v_mfma_f32_16x16x32_bf16 v[20:23], v[52:55], v[104:107], v[20:23]
  ds_read_b128 v[80:83], v3 offset:2688
  v_mfma_f32_16x16x32_bf16 v[24:27], v[52:55], v[108:111], v[24:27]
  ds_read_b128 v[144:147], v233 offset:4096
  v_mfma_f32_16x16x32_bf16 v[28:31], v[52:55], v[112:115], v[28:31]
  ds_read_b128 v[84:87], v3 offset:2176
  v_mfma_f32_16x16x32_bf16 v[32:35], v[52:55], v[116:119], 0
  ds_read_b128 v[148:151], v233 offset:6144
  s_waitcnt lgkmcnt(14)
  v_mfma_f32_16x16x32_bf16 v[24:27], v[40:43], v[120:123], v[24:27]
  ds_read_b128 v[88:91], v3 offset:1664
  v_mfma_f32_16x16x32_bf16 v[28:31], v[44:47], v[120:123], v[28:31]
  ds_read_b128 v[152:155], v233 offset:8192
  v_mfma_f32_16x16x32_bf16 v[32:35], v[48:51], v[120:123], v[32:35]
  ds_read_b128 v[92:95], v3 offset:1152
  v_mfma_f32_16x16x32_bf16 v[36:39], v[52:55], v[120:123], 0
  ds_read_b128 v[156:159], v233 offset:10240
  v_mfma_f32_16x16x32_bf16 v[24:27], v[56:59], v[104:107], v[24:27]
  ds_read_b128 v[96:99], v3 offset:640
  v_mfma_f32_16x16x32_bf16 v[28:31], v[56:59], v[108:111], v[28:31]
  ds_read_b128 v[160:163], v233 offset:12288
  v_mfma_f32_16x16x32_bf16 v[32:35], v[56:59], v[112:115], v[32:35]
  ds_read_b128 v[100:103], v3 offset:128
  v_mfma_f32_16x16x32_bf16 v[36:39], v[56:59], v[116:119], v[36:39]
  ds_read_b128 v[164:167], v233 offset:14336
  s_waitcnt lgkmcnt(15)
  v_mfma_f32_16x16x32_bf16 v[28:31], v[40:43], v[124:127], v[28:31]
  v_mfma_f32_16x16x32_bf16 v[32:35], v[44:47], v[124:127], v[32:35]
  v_mfma_f32_16x16x32_bf16 v[36:39], v[48:51], v[124:127], v[36:39]
  buffer_load_dword v249, v248, s[8:11], 0 offen sc1
  v_mfma_f32_16x16x32_bf16 v[28:31], v[60:63], v[104:107], v[28:31]
  v_mfma_f32_16x16x32_bf16 v[32:35], v[60:63], v[108:111], v[32:35]
  s_add_u32 m0, s72, 114688
  s_add_u32 s86, s70, 0
  buffer_load_dwordx4 v240, s[20:23], s86 offen lds
  v_mfma_f32_16x16x32_bf16 v[36:39], v[60:63], v[112:115], v[36:39]
  s_waitcnt lgkmcnt(15)
  v_mfma_f32_16x16x32_bf16 v[32:35], v[40:43], v[128:131], v[32:35]
  s_add_u32 m0, s72, 115712
  s_add_u32 s86, s70, 14336
  buffer_load_dwordx4 v240, s[20:23], s86 offen lds
  v_mfma_f32_16x16x32_bf16 v[36:39], v[44:47], v[128:131], v[36:39]
  v_mfma_f32_16x16x32_bf16 v[32:35], v[64:67], v[104:107], v[32:35]
  s_add_u32 m0, s72, 116736
  s_add_u32 s86, s70, 28672
  buffer_load_dwordx4 v240, s[20:23], s86 offen lds
  v_mfma_f32_16x16x32_bf16 v[36:39], v[64:67], v[108:111], v[36:39]
  s_waitcnt lgkmcnt(15)
  v_mfma_f32_16x16x32_bf16 v[36:39], v[40:43], v[132:135], v[36:39]
  s_add_u32 m0, s72, 117760
  s_add_u32 s86, s70, 43008
  buffer_load_dwordx4 v240, s[20:23], s86 offen lds
  v_mfma_f32_16x16x32_bf16 v[36:39], v[68:71], v[104:107], v[36:39]
  s_waitcnt lgkmcnt(0)
  v_mfma_f32_16x16x32_bf16 v[8:11], v[72:75], v[136:139], v[8:11]
  v_mfma_f32_16x16x32_bf16 v[12:15], v[72:75], v[140:143], v[12:15]
  v_mfma_f32_16x16x32_bf16 v[12:15], v[76:79], v[136:139], v[12:15]
  ds_read_b128 v[40:43], v3 offset:3648
  v_mfma_f32_16x16x32_bf16 v[16:19], v[76:79], v[140:143], v[16:19]
  ds_read_b128 v[104:107], v234 offset:0
  v_mfma_f32_16x16x32_bf16 v[16:19], v[72:75], v[144:147], v[16:19]
  ds_read_b128 v[44:47], v3 offset:3136
  v_mfma_f32_16x16x32_bf16 v[20:23], v[76:79], v[144:147], v[20:23]
  ds_read_b128 v[108:111], v234 offset:2048
  v_mfma_f32_16x16x32_bf16 v[16:19], v[80:83], v[136:139], v[16:19]
  ds_read_b128 v[48:51], v3 offset:2624
  v_mfma_f32_16x16x32_bf16 v[20:23], v[80:83], v[140:143], v[20:23]
  ds_read_b128 v[112:115], v234 offset:4096
  v_mfma_f32_16x16x32_bf16 v[24:27], v[80:83], v[144:147], v[24:27]
  ds_read_b128 v[52:55], v3 offset:2112
  v_mfma_f32_16x16x32_bf16 v[20:23], v[72:75], v[148:151], v[20:23]
  ds_read_b128 v[116:119], v234 offset:6144
  v_mfma_f32_16x16x32_bf16 v[24:27], v[76:79], v[148:151], v[24:27]
  ds_read_b128 v[56:59], v3 offset:1600
  v_mfma_f32_16x16x32_bf16 v[28:31], v[80:83], v[148:151], v[28:31]
  ds_read_b128 v[120:123], v234 offset:8192
  v_mfma_f32_16x16x32_bf16 v[20:23], v[84:87], v[136:139], v[20:23]
  ds_read_b128 v[60:63], v3 offset:1088
  v_mfma_f32_16x16x32_bf16 v[24:27], v[84:87], v[140:143], v[24:27]
  ds_read_b128 v[124:127], v234 offset:10240
  v_mfma_f32_16x16x32_bf16 v[28:31], v[84:87], v[144:147], v[28:31]
  ds_read_b128 v[64:67], v3 offset:576
  v_mfma_f32_16x16x32_bf16 v[32:35], v[84:87], v[148:151], v[32:35]
  ds_read_b128 v[128:131], v234 offset:12288
  v_mfma_f32_16x16x32_bf16 v[24:27], v[72:75], v[152:155], v[24:27]
  ds_read_b128 v[68:71], v3 offset:64
  v_mfma_f32_16x16x32_bf16 v[28:31], v[76:79], v[152:155], v[28:31]
  ds_read_b128 v[132:135], v234 offset:14336
  v_mfma_f32_16x16x32_bf16 v[32:35], v[80:83], v[152:155], v[32:35]
  ds_read_b64 v[168:169], v4 offset:0
  v_mfma_f32_16x16x32_bf16 v[36:39], v[84:87], v[152:155], v[36:39]
  ds_read_b64 v[176:177], v4 offset:512
  v_mfma_f32_16x16x32_bf16 v[24:27], v[88:91], v[136:139], v[24:27]
  s_add_u32 m0, s72, 131072
  s_add_u32 s86, s70, 229376
  buffer_load_dwordx4 v240, s[20:23], s86 offen lds
  v_mfma_f32_16x16x32_bf16 v[28:31], v[88:91], v[140:143], v[28:31]
  ds_read_b64 v[170:171], v4 offset:2048
  v_mfma_f32_16x16x32_bf16 v[32:35], v[88:91], v[144:147], v[32:35]
  s_add_u32 m0, s72, 132096
  s_add_u32 s86, s70, 243712
  buffer_load_dwordx4 v240, s[20:23], s86 offen lds
  v_mfma_f32_16x16x32_bf16 v[36:39], v[88:91], v[148:151], v[36:39]
  ds_read_b64 v[178:179], v4 offset:2560
  v_mfma_f32_16x16x32_bf16 v[28:31], v[72:75], v[156:159], v[28:31]
  s_add_u32 m0, s72, 133120
  s_add_u32 s86, s70, 258048
  buffer_load_dwordx4 v240, s[20:23], s86 offen lds
  v_mfma_f32_16x16x32_bf16 v[32:35], v[76:79], v[156:159], v[32:35]
  ds_read_b64 v[172:173], v4 offset:4096
  v_mfma_f32_16x16x32_bf16 v[36:39], v[80:83], v[156:159], v[36:39]
  s_add_u32 m0, s72, 134144
  s_add_u32 s86, s70, 272384
  buffer_load_dwordx4 v240, s[20:23], s86 offen lds
  v_mfma_f32_16x16x32_bf16 v[28:31], v[92:95], v[136:139], v[28:31]
  ds_read_b64 v[180:181], v4 offset:4608
  v_mfma_f32_16x16x32_bf16 v[32:35], v[92:95], v[140:143], v[32:35]
  s_add_u32 m0, s72, 147456
  s_add_u32 s86, s70, 458752
  buffer_load_dwordx4 v240, s[20:23], s86 offen lds
  v_mfma_f32_16x16x32_bf16 v[36:39], v[92:95], v[144:147], v[36:39]
  ds_read_b64 v[174:175], v4 offset:6144
  v_mfma_f32_16x16x32_bf16 v[32:35], v[72:75], v[160:163], v[32:35]
  s_add_u32 m0, s72, 148480
  s_add_u32 s86, s70, 473088
  buffer_load_dwordx4 v240, s[20:23], s86 offen lds
  v_mfma_f32_16x16x32_bf16 v[36:39], v[76:79], v[160:163], v[36:39]
  ds_read_b64 v[182:183], v4 offset:6656
  v_mfma_f32_16x16x32_bf16 v[32:35], v[96:99], v[136:139], v[32:35]
  s_add_u32 m0, s72, 149504
  s_add_u32 s86, s70, 487424
  buffer_load_dwordx4 v240, s[20:23], s86 offen lds
  v_mfma_f32_16x16x32_bf16 v[36:39], v[96:99], v[140:143], v[36:39]
  v_mfma_f32_16x16x32_bf16 v[36:39], v[72:75], v[164:167], v[36:39]
  s_add_u32 m0, s72, 150528
  s_add_u32 s86, s70, 501760
  buffer_load_dwordx4 v240, s[20:23], s86 offen lds
  v_mfma_f32_16x16x32_bf16 v[36:39], v[100:103], v[136:139], v[36:39]
  s_waitcnt lgkmcnt(0)
  v_mfma_f32_16x16x32_bf16 v[8:11], v[40:43], v[104:107], v[8:11]
  v_lshlrev_b32 v184, 16, v168
  v_and_b32 v185, s91, v168
  v_mfma_f32_16x16x32_bf16 v[12:15], v[40:43], v[108:111], v[12:15]
  v_lshlrev_b32 v186, 16, v169
  v_and_b32 v187, s91, v169
  v_mfma_f32_16x16x32_bf16 v[12:15], v[44:47], v[104:107], v[12:15]
  ds_read_b128 v[72:75], v3 offset:3584
  v_mfma_f32_16x16x32_bf16 v[16:19], v[44:47], v[108:111], v[16:19]
  ds_read_b128 v[136:139], v235 offset:0
  v_mfma_f32_16x16x32_bf16 v[16:19], v[40:43], v[112:115], v[16:19]
  ds_read_b128 v[76:79], v3 offset:3072
  v_mfma_f32_16x16x32_bf16 v[20:23], v[44:47], v[112:115], v[20:23]
  ds_read_b128 v[140:143], v235 offset:2048
  v_mfma_f32_16x16x32_bf16 v[16:19], v[48:51], v[104:107], v[16:19]
  ds_read_b128 v[80:83], v3 offset:2560
  v_mfma_f32_16x16x32_bf16 v[20:23], v[48:51], v[108:111], v[20:23]
  ds_read_b128 v[144:147], v235 offset:4096
  v_mfma_f32_16x16x32_bf16 v[24:27], v[48:51], v[112:115], v[24:27]
  ds_read_b128 v[84:87], v3 offset:2048
  v_mfma_f32_16x16x32_bf16 v[20:23], v[40:43], v[116:119], v[20:23]
  ds_read_b128 v[148:151], v235 offset:6144
  v_mfma_f32_16x16x32_bf16 v[24:27], v[44:47], v[116:119], v[24:27]
  ds_read_b128 v[88:91], v3 offset:1536
  v_mfma_f32_16x16x32_bf16 v[28:31], v[48:51], v[116:119], v[28:31]
  ds_read_b128 v[152:155], v235 offset:8192
  v_mfma_f32_16x16x32_bf16 v[20:23], v[52:55], v[104:107], v[20:23]
  ds_read_b128 v[92:95], v3 offset:1024
  v_mfma_f32_16x16x32_bf16 v[24:27], v[52:55], v[108:111], v[24:27]
  ds_read_b128 v[156:159], v235 offset:10240
  v_mfma_f32_16x16x32_bf16 v[28:31], v[52:55], v[112:115], v[28:31]
  ds_read_b128 v[96:99], v3 offset:512
  v_mfma_f32_16x16x32_bf16 v[32:35], v[52:55], v[116:119], v[32:35]
  ds_read_b128 v[160:163], v235 offset:12288
  v_mfma_f32_16x16x32_bf16 v[24:27], v[40:43], v[120:123], v[24:27]
  ds_read_b128 v[100:103], v3 offset:0
  v_mfma_f32_16x16x32_bf16 v[28:31], v[44:47], v[120:123], v[28:31]
  ds_read_b128 v[164:167], v235 offset:14336
  v_mfma_f32_16x16x32_bf16 v[32:35], v[48:51], v[120:123], v[32:35]
  v_mul_f32 v184, s84, v184
  v_mul_f32 v185, s84, v185
  v_mfma_f32_16x16x32_bf16 v[36:39], v[52:55], v[120:123], v[36:39]
  v_mul_f32 v186, s84, v186
  v_mul_f32 v187, s84, v187
  v_mfma_f32_16x16x32_bf16 v[24:27], v[56:59], v[104:107], v[24:27]
  s_mov_b32 s79, 0
  s_waitcnt vmcnt(12)
PW_loop:
  v_cmp_ne_u32 vcc, s29, v249
  s_cbranch_vccz PW_done
  s_add_u32 s79, s79, 1
  s_cmp_ge_u32 s79, 100000
  s_cbranch_scc1 PW_done
  s_sleep 1
  buffer_load_dword v249, v248, s[8:11], 0 offen sc1
  s_waitcnt vmcnt(0)
  s_branch PW_loop
PW_done:
  v_mfma_f32_16x16x32_bf16 v[28:31], v[56:59], v[108:111], v[28:31]
  v_cvt_pk_bf16_f32 v216, v184, v185
  v_cvt_pk_bf16_f32 v217, v186, v187
  v_mfma_f32_16x16x32_bf16 v[32:35], v[56:59], v[112:115], v[32:35]
  buffer_load_dwordx4 a[0:3], v247, s[8:11], s3 offen offset:0 sc1
  v_mfma_f32_16x16x32_bf16 v[36:39], v[56:59], v[116:119], v[36:39]
  v_lshlrev_b32 v188, 16, v176
  v_and_b32 v189, s91, v176
  v_mfma_f32_16x16x32_bf16 v[28:31], v[40:43], v[124:127], v[28:31]
  buffer_load_dwordx4 a[4:7], v247, s[8:11], s3 offen offset:1024 sc1
  v_mfma_f32_16x16x32_bf16 v[32:35], v[44:47], v[124:127], v[32:35]
  v_lshlrev_b32 v190, 16, v177
  v_and_b32 v191, s91, v177
  v_mfma_f32_16x16x32_bf16 v[36:39], v[48:51], v[124:127], v[36:39]
  buffer_load_dwordx4 a[8:11], v247, s[8:11], s3 offen offset:2048 sc1
  v_mfma_f32_16x16x32_bf16 v[28:31], v[60:63], v[104:107], v[28:31]
  v_lshlrev_b32 v184, 16, v216
  v_and_b32 v185, s91, v216
  v_mfma_f32_16x16x32_bf16 v[32:35], v[60:63], v[108:111], v[32:35]
  buffer_load_dwordx4 a[12:15], v247, s[8:11], s3 offen offset:3072 sc1
  v_mfma_f32_16x16x32_bf16 v[36:39], v[60:63], v[112:115], v[36:39]
  v_lshlrev_b32 v186, 16, v217
  v_and_b32 v187, s91, v217
  v_mfma_f32_16x16x32_bf16 v[32:35], v[40:43], v[128:131], v[32:35]
  s_add_u32 s3, s3, 4096
  buffer_load_dwordx4 a[16:19], v247, s[8:11], s3 offen offset:0 sc1
  v_mfma_f32_16x16x32_bf16 v[36:39], v[44:47], v[128:131], v[36:39]
  v_lshlrev_b32 v192, 16, v170
  v_and_b32 v193, s91, v170
  v_mfma_f32_16x16x32_bf16 v[32:35], v[64:67], v[104:107], v[32:35]
  buffer_load_dwordx4 a[20:23], v247, s[8:11], s3 offen offset:1024 sc1
  v_mfma_f32_16x16x32_bf16 v[36:39], v[64:67], v[108:111], v[36:39]
  v_lshlrev_b32 v194, 16, v171
  v_and_b32 v195, s91, v171
  v_mfma_f32_16x16x32_bf16 v[36:39], v[40:43], v[132:135], v[36:39]
  buffer_load_dwordx4 a[24:27], v247, s[8:11], s3 offen offset:2048 sc1
  v_mfma_f32_16x16x32_bf16 v[36:39], v[68:71], v[104:107], v[36:39]
  v_mul_f32 v192, s84, v192
  v_mul_f32 v193, s84, v193
  s_cmp_eq_u32 s81, 0
  s_cbranch_scc1 CV_lo
  s_waitcnt lgkmcnt(0)
  v_mfma_f32_16x16x32_bf16 v[20:23], v[76:79], v[144:147], v[20:23]
  v_mul_f32 v194, s84, v194
  v_mul_f32 v195, s84, v195
  v_mfma_f32_16x16x32_bf16 v[16:19], v[76:79], v[140:143], v[16:19]
  v_cvt_pk_bf16_f32 v216, v192, v193
  v_cvt_pk_bf16_f32 v217, v194, v195
  v_mfma_f32_16x16x32_bf16 v[12:15], v[72:75], v[140:143], v[12:15]
  buffer_load_dwordx4 a[28:31], v247, s[8:11], s3 offen offset:3072 sc1
  v_mfma_f32_16x16x32_bf16 v[20:23], v[80:83], v[140:143], v[20:23]
  v_lshlrev_b32 v196, 16, v178
  v_and_b32 v197, s91, v178
  v_mfma_f32_16x16x32_bf16 v[16:19], v[72:75], v[144:147], v[16:19]
  s_add_u32 s3, s3, 4096
  buffer_load_dwordx4 a[32:35], v247, s[8:11], s3 offen offset:0 sc1
  v_mfma_f32_16x16x32_bf16 v[8:11], v[72:75], v[136:139], v[8:11]
  v_lshlrev_b32 v198, 16, v179
  v_and_b32 v199, s91, v179
  v_mfma_f32_16x16x32_bf16 v[20:23], v[72:75], v[148:151], v[20:23]
  buffer_load_dwordx4 a[36:39], v247, s[8:11], s3 offen offset:1024 sc1
  v_mfma_f32_16x16x32_bf16 v[12:15], v[76:79], v[136:139], v[12:15]
  v_lshlrev_b32 v192, 16, v216
  v_and_b32 v193, s91, v216
  v_mfma_f32_16x16x32_bf16 v[16:19], v[80:83], v[136:139], v[16:19]
  buffer_load_dwordx4 a[40:43], v247, s[8:11], s3 offen offset:2048 sc1
  v_mfma_f32_16x16x32_bf16 v[20:23], v[84:87], v[136:139], v[20:23]
  v_lshlrev_b32 v194, 16, v217
  v_and_b32 v195, s91, v217
  v_mfma_f32_16x16x32_bf16 v[36:39], v[84:87], v[152:155], v[36:39]
  buffer_load_dwordx4 a[44:47], v247, s[8:11], s3 offen offset:3072 sc1
  v_mfma_f32_16x16x32_bf16 v[32:35], v[84:87], v[148:151], v[32:35]
  v_lshlrev_b32 v200, 16, v172
  v_and_b32 v201, s91, v172
  v_mfma_f32_16x16x32_bf16 v[28:31], v[80:83], v[148:151], v[28:31]
  s_add_u32 s3, s3, 4096
  buffer_load_dwordx4 a[48:51], v247, s[8:11], s3 offen offset:0 sc1
  v_mfma_f32_16x16x32_bf16 v[36:39], v[88:91], v[148:151], v[36:39]
  ds_write_b128 v6, v[8:11] offset:0
  v_mfma_f32_16x16x32_bf16 v[32:35], v[80:83], v[152:155], v[32:35]
  buffer_load_dwordx4 a[52:55], v247, s[8:11], s3 offen offset:1024 sc1
  v_mfma_f32_16x16x32_bf16 v[24:27], v[80:83], v[144:147], v[24:27]
  ds_write_b128 v6, v[12:15] offset:1024
  v_mfma_f32_16x16x32_bf16 v[36:39], v[80:83], v[156:159], v[36:39]
  buffer_load_dwordx4 a[56:59], v247, s[8:11], s3 offen offset:2048 sc1
  v_mfma_f32_16x16x32_bf16 v[28:31], v[84:87], v[144:147], v[28:31]
  ds_write_b128 v6, v[16:19] offset:2048
  v_mfma_f32_16x16x32_bf16 v[32:35], v[88:91], v[144:147], v[32:35]
  buffer_load_dwordx4 a[60:63], v247, s[8:11], s3 offen offset:3072 sc1
  v_mfma_f32_16x16x32_bf16 v[36:39], v[92:95], v[144:147], v[36:39]
  ds_write_b128 v6, v[20:23] offset:3072
  v_mfma_f32_16x16x32_bf16 v[24:27], v[76:79], v[148:151], v[24:27]
  v_lshlrev_b32 v202, 16, v173
  v_and_b32 v203, s91, v173
  v_mfma_f32_16x16x32_bf16 v[28:31], v[76:79], v[152:155], v[28:31]
  v_mul_f32 v200, s84, v200
  v_mul_f32 v201, s84, v201
  v_mfma_f32_16x16x32_bf16 v[32:35], v[76:79], v[156:159], v[32:35]
  v_mul_f32 v202, s84, v202
  v_mul_f32 v203, s84, v203
  v_mfma_f32_16x16x32_bf16 v[36:39], v[76:79], v[160:163], v[36:39]
  v_cvt_pk_bf16_f32 v216, v200, v201
  v_cvt_pk_bf16_f32 v217, v202, v203
  v_mfma_f32_16x16x32_bf16 v[24:27], v[84:87], v[140:143], v[24:27]
  v_lshlrev_b32 v204, 16, v180
  v_and_b32 v205, s91, v180
  v_mfma_f32_16x16x32_bf16 v[28:31], v[88:91], v[140:143], v[28:31]
  v_lshlrev_b32 v206, 16, v181
  v_and_b32 v207, s91, v181
  v_mfma_f32_16x16x32_bf16 v[32:35], v[92:95], v[140:143], v[32:35]
  v_lshlrev_b32 v200, 16, v216
  v_and_b32 v201, s91, v216
  v_mfma_f32_16x16x32_bf16 v[36:39], v[96:99], v[140:143], v[36:39]
  v_lshlrev_b32 v202, 16, v217
  v_and_b32 v203, s91, v217
  v_mfma_f32_16x16x32_bf16 v[24:27], v[72:75], v[152:155], v[24:27]
  v_lshlrev_b32 v208, 16, v174
  v_and_b32 v209, s91, v174
  v_mfma_f32_16x16x32_bf16 v[28:31], v[72:75], v[156:159], v[28:31]
  v_lshlrev_b32 v210, 16, v175
  v_and_b32 v211, s91, v175
  v_mfma_f32_16x16x32_bf16 v[32:35], v[72:75], v[160:163], v[32:35]
  v_mul_f32 v208, s84, v208
  v_mul_f32 v209, s84, v209
  v_mfma_f32_16x16x32_bf16 v[36:39], v[72:75], v[164:167], v[36:39]
  v_mul_f32 v210, s84, v210
  v_mul_f32 v211, s84, v211
  v_mfma_f32_16x16x32_bf16 v[24:27], v[88:91], v[136:139], v[24:27]
  v_cvt_pk_bf16_f32 v216, v208, v209
  v_cvt_pk_bf16_f32 v217, v210, v211
  v_mfma_f32_16x16x32_bf16 v[28:31], v[92:95], v[136:139], v[28:31]
  v_lshlrev_b32 v212, 16, v182
  v_and_b32 v213, s91, v182
  v_mfma_f32_16x16x32_bf16 v[32:35], v[96:99], v[136:139], v[32:35]
  v_lshlrev_b32 v214, 16, v183
  v_and_b32 v215, s91, v183
  v_mfma_f32_16x16x32_bf16 v[36:39], v[100:103], v[136:139], v[36:39]
  v_lshlrev_b32 v208, 16, v216
  v_and_b32 v209, s91, v216
  v_lshlrev_b32 v210, 16, v217
  v_and_b32 v211, s91, v217
  s_waitcnt lgkmcnt(0)
  s_barrier
  ds_read_b128 v[8:11], v5 offset:0
  ds_read_b128 v[12:15], v5 offset:1024
  ds_read_b128 v[16:19], v5 offset:2048
  ds_read_b128 v[20:23], v5 offset:3072
  s_waitcnt lgkmcnt(3)
  v_pk_add_f32 v[24:25], v[24:25], v[8:9]
  v_pk_add_f32 v[26:27], v[26:27], v[10:11]
  v_cvt_pk_bf16_f32 v216, v24, v25
  v_lshlrev_b32 v24, 16, v216
  v_and_b32 v25, s91, v216
  v_cvt_pk_bf16_f32 v217, v26, v27
  v_lshlrev_b32 v26, 16, v217
  v_and_b32 v27, s91, v217
  v_pk_add_f32 v[24:25], v[24:25], v[184:185]
  v_pk_add_f32 v[26:27], v[26:27], v[186:187]
  v_cvt_pk_bf16_f32 v216, v24, v25
  v_lshlrev_b32 v24, 16, v216
  v_and_b32 v25, s91, v216
  v_cvt_pk_bf16_f32 v217, v26, v27
  v_lshlrev_b32 v26, 16, v217
  v_and_b32 v27, s91, v217
  v_pk_add_f32 v[24:25], v[24:25], v[188:189]
  v_pk_add_f32 v[26:27], v[26:27], v[190:191]
  v_cvt_pk_bf16_f32 v218, v24, v25
  v_cvt_pk_bf16_f32 v219, v26, v27
  buffer_store_dwordx2 v[218:219], v226, s[12:15], s82 offen sc1
  s_add_u32 s82, s82, 229376
  s_waitcnt lgkmcnt(2)
  v_pk_add_f32 v[28:29], v[28:29], v[12:13]
  v_pk_add_f32 v[30:31], v[30:31], v[14:15]
  v_cvt_pk_bf16_f32 v216, v28, v29
  v_lshlrev_b32 v28, 16, v216
  v_and_b32 v29, s91, v216
  v_cvt_pk_bf16_f32 v217, v30, v31
  v_lshlrev_b32 v30, 16, v217
  v_and_b32 v31, s91, v217
  v_pk_add_f32 v[28:29], v[28:29], v[192:193]
  v_pk_add_f32 v[30:31], v[30:31], v[194:195]
  v_cvt_pk_bf16_f32 v216, v28, v29
  v_lshlrev_b32 v28, 16, v216
  v_and_b32 v29, s91, v216
  v_cvt_pk_bf16_f32 v217, v30, v31
  v_lshlrev_b32 v30, 16, v217
  v_and_b32 v31, s91, v217
  v_pk_add_f32 v[28:29], v[28:29], v[196:197]
  v_pk_add_f32 v[30:31], v[30:31], v[198:199]
  v_cvt_pk_bf16_f32 v220, v28, v29
  v_cvt_pk_bf16_f32 v221, v30, v31
  buffer_store_dwordx2 v[220:221], v226, s[12:15], s82 offen sc1
  s_add_u32 s82, s82, 229376
  s_waitcnt lgkmcnt(1)
  v_pk_add_f32 v[32:33], v[32:33], v[16:17]
  v_pk_add_f32 v[34:35], v[34:35], v[18:19]
  v_cvt_pk_bf16_f32 v216, v32, v33
  v_lshlrev_b32 v32, 16, v216
  v_and_b32 v33, s91, v216
  v_cvt_pk_bf16_f32 v217, v34, v35
  v_lshlrev_b32 v34, 16, v217
  v_and_b32 v35, s91, v217
  v_pk_add_f32 v[32:33], v[32:33], v[200:201]
  v_pk_add_f32 v[34:35], v[34:35], v[202:203]
  v_cvt_pk_bf16_f32 v216, v32, v33
  v_lshlrev_b32 v32, 16, v216
  v_and_b32 v33, s91, v216
  v_cvt_pk_bf16_f32 v217, v34, v35
  v_lshlrev_b32 v34, 16, v217
  v_and_b32 v35, s91, v217
  v_pk_add_f32 v[32:33], v[32:33], v[204:205]
  v_pk_add_f32 v[34:35], v[34:35], v[206:207]
  v_cvt_pk_bf16_f32 v222, v32, v33
  v_cvt_pk_bf16_f32 v223, v34, v35
  buffer_store_dwordx2 v[222:223], v226, s[12:15], s82 offen sc1
  s_add_u32 s82, s82, 229376
  s_waitcnt lgkmcnt(0)
  v_pk_add_f32 v[36:37], v[36:37], v[20:21]
  v_pk_add_f32 v[38:39], v[38:39], v[22:23]
  v_cvt_pk_bf16_f32 v216, v36, v37
  v_lshlrev_b32 v36, 16, v216
  v_and_b32 v37, s91, v216
  v_cvt_pk_bf16_f32 v217, v38, v39
  v_lshlrev_b32 v38, 16, v217
  v_and_b32 v39, s91, v217
  v_pk_add_f32 v[36:37], v[36:37], v[208:209]
  v_pk_add_f32 v[38:39], v[38:39], v[210:211]
  v_cvt_pk_bf16_f32 v216, v36, v37
  v_lshlrev_b32 v36, 16, v216
  v_and_b32 v37, s91, v216
  v_cvt_pk_bf16_f32 v217, v38, v39
  v_lshlrev_b32 v38, 16, v217
  v_and_b32 v39, s91, v217
  v_pk_add_f32 v[36:37], v[36:37], v[212:213]
  v_pk_add_f32 v[38:39], v[38:39], v[214:215]
  v_cvt_pk_bf16_f32 v224, v36, v37
  v_cvt_pk_bf16_f32 v225, v38, v39
  buffer_store_dwordx2 v[224:225], v226, s[12:15], s82 offen sc1
  s_branch CV_end
CV_lo:
  s_waitcnt lgkmcnt(0)
  v_mfma_f32_16x16x32_bf16 v[36:39], v[84:87], v[152:155], v[36:39]
  v_mul_f32 v194, s84, v194
  v_mul_f32 v195, s84, v195
  v_mfma_f32_16x16x32_bf16 v[32:35], v[84:87], v[148:151], v[32:35]
  v_cvt_pk_bf16_f32 v216, v192, v193
  v_cvt_pk_bf16_f32 v217, v194, v195
  v_mfma_f32_16x16x32_bf16 v[28:31], v[80:83], v[148:151], v[28:31]
  buffer_load_dwordx4 a[28:31], v247, s[8:11], s3 offen offset:3072 sc1
  v_mfma_f32_16x16x32_bf16 v[36:39], v[88:91], v[148:151], v[36:39]
  v_lshlrev_b32 v196, 16, v178
  v_and_b32 v197, s91, v178
  v_mfma_f32_16x16x32_bf16 v[32:35], v[80:83], v[152:155], v[32:35]
  s_add_u32 s3, s3, 4096
  buffer_load_dwordx4 a[32:35], v247, s[8:11], s3 offen offset:0 sc1
  v_mfma_f32_16x16x32_bf16 v[24:27], v[80:83], v[144:147], v[24:27]
  v_lshlrev_b32 v198, 16, v179
  v_and_b32 v199, s91, v179
  v_mfma_f32_16x16x32_bf16 v[36:39], v[80:83], v[156:159], v[36:39]
  buffer_load_dwordx4 a[36:39], v247, s[8:11], s3 offen offset:1024 sc1
  v_mfma_f32_16x16x32_bf16 v[28:31], v[84:87], v[144:147], v[28:31]
  v_lshlrev_b32 v192, 16, v216
  v_and_b32 v193, s91, v216
  v_mfma_f32_16x16x32_bf16 v[32:35], v[88:91], v[144:147], v[32:35]
  buffer_load_dwordx4 a[40:43], v247, s[8:11], s3 offen offset:2048 sc1
  v_mfma_f32_16x16x32_bf16 v[36:39], v[92:95], v[144:147], v[36:39]
  v_lshlrev_b32 v194, 16, v217
  v_and_b32 v195, s91, v217
  v_mfma_f32_16x16x32_bf16 v[24:27], v[76:79], v[148:151], v[24:27]
  buffer_load_dwordx4 a[44:47], v247, s[8:11], s3 offen offset:3072 sc1
  v_mfma_f32_16x16x32_bf16 v[28:31], v[76:79], v[152:155], v[28:31]
  v_lshlrev_b32 v200, 16, v172
  v_and_b32 v201, s91, v172
  v_mfma_f32_16x16x32_bf16 v[32:35], v[76:79], v[156:159], v[32:35]
  s_add_u32 s3, s3, 4096
  buffer_load_dwordx4 a[48:51], v247, s[8:11], s3 offen offset:0 sc1
  v_mfma_f32_16x16x32_bf16 v[36:39], v[76:79], v[160:163], v[36:39]
  v_lshlrev_b32 v202, 16, v173
  v_and_b32 v203, s91, v173
  v_mfma_f32_16x16x32_bf16 v[24:27], v[84:87], v[140:143], v[24:27]
  buffer_load_dwordx4 a[52:55], v247, s[8:11], s3 offen offset:1024 sc1
  v_mfma_f32_16x16x32_bf16 v[28:31], v[88:91], v[140:143], v[28:31]
  v_mul_f32 v200, s84, v200
  v_mul_f32 v201, s84, v201
  v_mfma_f32_16x16x32_bf16 v[32:35], v[92:95], v[140:143], v[32:35]
  buffer_load_dwordx4 a[56:59], v247, s[8:11], s3 offen offset:2048 sc1
  v_mfma_f32_16x16x32_bf16 v[36:39], v[96:99], v[140:143], v[36:39]
  v_mul_f32 v202, s84, v202
  v_mul_f32 v203, s84, v203
  v_mfma_f32_16x16x32_bf16 v[24:27], v[72:75], v[152:155], v[24:27]
  buffer_load_dwordx4 a[60:63], v247, s[8:11], s3 offen offset:3072 sc1
  v_mfma_f32_16x16x32_bf16 v[28:31], v[72:75], v[156:159], v[28:31]
  v_cvt_pk_bf16_f32 v216, v200, v201
  v_cvt_pk_bf16_f32 v217, v202, v203
  v_mfma_f32_16x16x32_bf16 v[32:35], v[72:75], v[160:163], v[32:35]
  v_lshlrev_b32 v204, 16, v180
  v_and_b32 v205, s91, v180
  v_mfma_f32_16x16x32_bf16 v[36:39], v[72:75], v[164:167], v[36:39]
  v_lshlrev_b32 v206, 16, v181
  v_and_b32 v207, s91, v181
  v_mfma_f32_16x16x32_bf16 v[24:27], v[88:91], v[136:139], v[24:27]
  v_lshlrev_b32 v200, 16, v216
  v_and_b32 v201, s91, v216
  v_mfma_f32_16x16x32_bf16 v[28:31], v[92:95], v[136:139], v[28:31]
  v_lshlrev_b32 v202, 16, v217
  v_and_b32 v203, s91, v217
  v_mfma_f32_16x16x32_bf16 v[32:35], v[96:99], v[136:139], v[32:35]
  v_lshlrev_b32 v208, 16, v174
  v_and_b32 v209, s91, v174
  v_mfma_f32_16x16x32_bf16 v[36:39], v[100:103], v[136:139], v[36:39]
  v_lshlrev_b32 v210, 16, v175
  v_and_b32 v211, s91, v175
  v_mfma_f32_16x16x32_bf16 v[20:23], v[76:79], v[144:147], v[20:23]
  v_mul_f32 v208, s84, v208
  v_mul_f32 v209, s84, v209
  v_mfma_f32_16x16x32_bf16 v[16:19], v[76:79], v[140:143], v[16:19]
  v_mul_f32 v210, s84, v210
  v_mul_f32 v211, s84, v211
  v_mfma_f32_16x16x32_bf16 v[12:15], v[72:75], v[140:143], v[12:15]
  ds_write_b128 v6, v[24:27] offset:0
  v_mfma_f32_16x16x32_bf16 v[20:23], v[80:83], v[140:143], v[20:23]
  ds_write_b128 v6, v[28:31] offset:1024
  v_mfma_f32_16x16x32_bf16 v[16:19], v[72:75], v[144:147], v[16:19]
  ds_write_b128 v6, v[32:35] offset:2048
  v_mfma_f32_16x16x32_bf16 v[8:11], v[72:75], v[136:139], v[8:11]
  ds_write_b128 v6, v[36:39] offset:3072
  v_mfma_f32_16x16x32_bf16 v[20:23], v[72:75], v[148:151], v[20:23]
  v_cvt_pk_bf16_f32 v216, v208, v209
  v_cvt_pk_bf16_f32 v217, v210, v211
  v_mfma_f32_16x16x32_bf16 v[12:15], v[76:79], v[136:139], v[12:15]
  v_lshlrev_b32 v212, 16, v182
  v_and_b32 v213, s91, v182
  v_mfma_f32_16x16x32_bf16 v[16:19], v[80:83], v[136:139], v[16:19]
  v_lshlrev_b32 v214, 16, v183
  v_and_b32 v215, s91, v183
  v_mfma_f32_16x16x32_bf16 v[20:23], v[84:87], v[136:139], v[20:23]
  v_lshlrev_b32 v208, 16, v216
  v_and_b32 v209, s91, v216
  v_lshlrev_b32 v210, 16, v217
  v_and_b32 v211, s91, v217
  s_waitcnt lgkmcnt(0)
  s_barrier
  ds_read_b128 v[24:27], v5 offset:0
  ds_read_b128 v[28:31], v5 offset:1024
  ds_read_b128 v[32:35], v5 offset:2048
  ds_read_b128 v[36:39], v5 offset:3072
  s_waitcnt lgkmcnt(3)
  v_pk_add_f32 v[8:9], v[8:9], v[24:25]
  v_pk_add_f32 v[10:11], v[10:11], v[26:27]
  v_cvt_pk_bf16_f32 v216, v8, v9
  v_lshlrev_b32 v8, 16, v216
  v_and_b32 v9, s91, v216
  v_cvt_pk_bf16_f32 v217, v10, v11
  v_lshlrev_b32 v10, 16, v217
  v_and_b32 v11, s91, v217
  v_pk_add_f32 v[8:9], v[8:9], v[184:185]
  v_pk_add_f32 v[10:11], v[10:11], v[186:187]
  v_cvt_pk_bf16_f32 v216, v8, v9
  v_lshlrev_b32 v8, 16, v216
  v_and_b32 v9, s91, v216
  v_cvt_pk_bf16_f32 v217, v10, v11
  v_lshlrev_b32 v10, 16, v217
  v_and_b32 v11, s91, v217
  v_pk_add_f32 v[8:9], v[8:9], v[188:189]
  v_pk_add_f32 v[10:11], v[10:11], v[190:191]
  v_cvt_pk_bf16_f32 v218, v8, v9
  v_cvt_pk_bf16_f32 v219, v10, v11
  buffer_store_dwordx2 v[218:219], v226, s[12:15], s82 offen sc1
  s_add_u32 s82, s82, 229376
  s_waitcnt lgkmcnt(2)
  v_pk_add_f32 v[12:13], v[12:13], v[28:29]
  v_pk_add_f32 v[14:15], v[14:15], v[30:31]
  v_cvt_pk_bf16_f32 v216, v12, v13
  v_lshlrev_b32 v12, 16, v216
  v_and_b32 v13, s91, v216
  v_cvt_pk_bf16_f32 v217, v14, v15
  v_lshlrev_b32 v14, 16, v217
  v_and_b32 v15, s91, v217
  v_pk_add_f32 v[12:13], v[12:13], v[192:193]
  v_pk_add_f32 v[14:15], v[14:15], v[194:195]
  v_cvt_pk_bf16_f32 v216, v12, v13
  v_lshlrev_b32 v12, 16, v216
  v_and_b32 v13, s91, v216
  v_cvt_pk_bf16_f32 v217, v14, v15
  v_lshlrev_b32 v14, 16, v217
  v_and_b32 v15, s91, v217
  v_pk_add_f32 v[12:13], v[12:13], v[196:197]
  v_pk_add_f32 v[14:15], v[14:15], v[198:199]
  v_cvt_pk_bf16_f32 v220, v12, v13
  v_cvt_pk_bf16_f32 v221, v14, v15
  buffer_store_dwordx2 v[220:221], v226, s[12:15], s82 offen sc1
  s_add_u32 s82, s82, 229376
  s_waitcnt lgkmcnt(1)
  v_pk_add_f32 v[16:17], v[16:17], v[32:33]
  v_pk_add_f32 v[18:19], v[18:19], v[34:35]
  v_cvt_pk_bf16_f32 v216, v16, v17
  v_lshlrev_b32 v16, 16, v216
  v_and_b32 v17, s91, v216
  v_cvt_pk_bf16_f32 v217, v18, v19
  v_lshlrev_b32 v18, 16, v217
  v_and_b32 v19, s91, v217
  v_pk_add_f32 v[16:17], v[16:17], v[200:201]
  v_pk_add_f32 v[18:19], v[18:19], v[202:203]
  v_cvt_pk_bf16_f32 v216, v16, v17
  v_lshlrev_b32 v16, 16, v216
  v_and_b32 v17, s91, v216
  v_cvt_pk_bf16_f32 v217, v18, v19
  v_lshlrev_b32 v18, 16, v217
  v_and_b32 v19, s91, v217
  v_pk_add_f32 v[16:17], v[16:17], v[204:205]
  v_pk_add_f32 v[18:19], v[18:19], v[206:207]
  v_cvt_pk_bf16_f32 v222, v16, v17
  v_cvt_pk_bf16_f32 v223, v18, v19
  buffer_store_dwordx2 v[222:223], v226, s[12:15], s82 offen sc1
  s_add_u32 s82, s82, 229376
  s_waitcnt lgkmcnt(0)
  v_pk_add_f32 v[20:21], v[20:21], v[36:37]
  v_pk_add_f32 v[22:23], v[22:23], v[38:39]
  v_cvt_pk_bf16_f32 v216, v20, v21
  v_lshlrev_b32 v20, 16, v216
  v_and_b32 v21, s91, v216
  v_cvt_pk_bf16_f32 v217, v22, v23
  v_lshlrev_b32 v22, 16, v217
  v_and_b32 v23, s91, v217
  v_pk_add_f32 v[20:21], v[20:21], v[208:209]
  v_pk_add_f32 v[22:23], v[22:23], v[210:211]
  v_cvt_pk_bf16_f32 v216, v20, v21
  v_lshlrev_b32 v20, 16, v216
  v_and_b32 v21, s91, v216
  v_cvt_pk_bf16_f32 v217, v22, v23
  v_lshlrev_b32 v22, 16, v217
  v_and_b32 v23, s91, v217
  v_pk_add_f32 v[20:21], v[20:21], v[212:213]
  v_pk_add_f32 v[22:23], v[22:23], v[214:215]
  v_cvt_pk_bf16_f32 v224, v20, v21
  v_cvt_pk_bf16_f32 v225, v22, v23
  buffer_store_dwordx2 v[224:225], v226, s[12:15], s82 offen sc1
CV_end:
  v_and_b32 v1, 63, v0
  v_bfe_u32 v8, v1, 2, 2
  v_lshrrev_b32 v9, 5, v1
  v_lshl_add_u32 v9, v9, 2, v8
  v_lshlrev_b32 v9, 8, v9
  v_bfe_u32 v10, v1, 4, 1
  v_lshl_add_u32 v9, v10, 5, v9
  v_and_b32 v10, 3, v1
  v_lshl_add_u32 v9, v10, 3, v9
  s_lshl_b32 s80, s74, 1
  s_add_u32 s80, s80, 0
  v_xor_b32 v10, s80, v8
  v_lshl_add_u32 v4, v10, 6, v9
  s_lshl_b32 s80, s74, 1
  s_add_u32 s80, s80, 1
  v_xor_b32 v10, s80, v8
  v_lshl_add_u32 v5, v10, 6, v9
  s_lshl_b32 s80, s73, 1
  s_xor_b32 s81, s74, 0
  s_add_u32 s80, s80, s81
  v_xor_b32 v10, s80, v8
  v_lshl_add_u32 v6, v10, 6, v9
  s_lshl_b32 s80, s73, 1
  s_xor_b32 s81, s74, 1
  s_add_u32 s80, s80, s81
  v_xor_b32 v10, s80, v8
  v_lshl_add_u32 v7, v10, 6, v9
  v_add_u32 v16, 0x10000, v4
  v_add_u32 v18, 0x20000, v4
  v_add_u32 v20, 0x10000, v6
  v_add_u32 v22, 0x20000, v6
  v_add_u32 v17, 0x10000, v5
  v_add_u32 v19, 0x20000, v5
  v_add_u32 v21, 0x10000, v7
  v_add_u32 v23, 0x20000, v7
  v_and_b32 v8, 63, v0
  v_lshrrev_b32 v9, 3, v8
  v_and_b32 v10, 7, v8
  v_bfe_u32 v11, v9, 1, 1
  v_lshlrev_b32 v11, 2, v11
  v_xor_b32 v10, v10, v11
  v_lshlrev_b32 v10, 4, v10
  v_mul_u32_u24 v242, 896, v9
  v_add_u32 v242, v242, v10
  v_lshl_add_u32 v243, v9, 8, v10
  v_lshlrev_b32 v247, 4, v8
  s_mul_i32 s75, s28, 401408
  s_lshl_b32 s80, s35, 7
  s_add_u32 s75, s75, s80
  s_mul_i32 s76, s34, 229376
  s_mul_i32 s80, s28, 57344
  s_add_u32 s76, s76, s80
  s_mul_i32 s77, s28, 36864
  v_bfe_u32 v9, v8, 2, 2
  v_lshrrev_b32 v10, 5, v8
  v_lshl_add_u32 v10, v10, 2, v9
  v_lshlrev_b32 v10, 7, v10
  v_bfe_u32 v11, v8, 4, 1
  v_lshl_add_u32 v10, v11, 5, v10
  v_and_b32 v11, 3, v8
  v_lshl_add_u32 v10, v11, 3, v10
  v_lshrrev_b32 v9, 1, v9
  v_lshl_add_u32 v244, v9, 6, v10
  v_xor_b32 v245, 64, v244
  s_and_b32 s78, s28, 1
  s_lshr_b32 s79, s28, 1
  s_lshl_b32 s80, s79, 6
  v_xor_b32 v246, s80, v244
  s_lshl_b32 s80, s78, 12
  s_add_u32 s80, s80, 147456
  v_add_u32 v246, s80, v246
  v_add_u32 v244, s77, v244
  v_add_u32 v245, s77, v245
  s_mul_i32 s87, s30, 32
  s_add_u32 s87, s87, 14745600
  v_and_b32 v1, 63, v0
  s_and_b32 s80, s2, 7
  s_mul_i32 s80, s80, 8192
  s_add_u32 s80, s80, 14745600
  v_mul_u32_u24 v56, 32, v1
  s_add_u32 s81, s80, 0
  v_add_u32 v56, s81, v56
  v_mul_u32_u24 v57, 32, v1
  s_add_u32 s81, s80, 1792
  v_add_u32 v57, s81, v57
  v_mul_u32_u24 v58, 32, v1
  s_add_u32 s81, s80, 3584
  v_add_u32 v58, s81, v58
  v_mul_u32_u24 v59, 32, v1
  s_add_u32 s81, s80, 5376
  v_add_u32 v59, s81, v59
  s_lshl_b32 s80, s32, 4
  s_add_u32 s80, s80, 15826944
  v_cmp_gt_u32 vcc, 56, v1
  s_add_u32 s81, s80, 0
  v_mov_b32 v1, s81
  v_cndmask_b32 v56, v1, v56, vcc
  s_add_u32 s81, s80, 4
  v_mov_b32 v1, s81
  v_cndmask_b32 v57, v1, v57, vcc
  s_add_u32 s81, s80, 8
  v_mov_b32 v1, s81
  v_cndmask_b32 v58, v1, v58, vcc
  s_add_u32 s81, s80, 12
  v_mov_b32 v1, s81
  v_cndmask_b32 v59, v1, v59, vcc
  s_waitcnt vmcnt(0)
  s_barrier
  s_cmp_lg_u32 s28, 0
  s_cbranch_scc1 S2_skip
  v_and_b32 v8, 63, v0
  v_mul_u32_u24 v8, 8192, v8
  v_mov_b32 v10, s29
  v_mov_b32 v11, s29
  s_mov_b64 exec, 0xff
  buffer_store_dword v10, v8, s[8:11], s87 offen sc1
  s_mov_b64 exec, -1
S2_skip:
  s_add_u32 m0, s72, 32768
  s_add_u32 s86, s70, 688128
  buffer_load_dwordx4 v240, s[20:23], s86 offen lds
  s_add_u32 m0, s72, 33792
  s_add_u32 s86, s70, 702464
  buffer_load_dwordx4 v240, s[20:23], s86 offen lds
  s_add_u32 m0, s72, 34816
  s_add_u32 s86, s70, 716800
  buffer_load_dwordx4 v240, s[20:23], s86 offen lds
  s_add_u32 m0, s72, 35840
  s_add_u32 s86, s70, 731136
  buffer_load_dwordx4 v240, s[20:23], s86 offen lds
  s_add_u32 m0, s72, 49152
  s_add_u32 s86, s70, 917504
  buffer_load_dwordx4 v240, s[20:23], s86 offen lds
  s_add_u32 m0, s72, 50176
  s_add_u32 s86, s70, 931840
  buffer_load_dwordx4 v240, s[20:23], s86 offen lds
  s_add_u32 m0, s72, 51200
  s_add_u32 s86, s70, 946176
  buffer_load_dwordx4 v240, s[20:23], s86 offen lds
  s_add_u32 m0, s72, 52224
  s_add_u32 s86, s70, 960512
  buffer_load_dwordx4 v240, s[20:23], s86 offen lds
  s_add_u32 s3, s3, 4096
  buffer_load_dwordx4 a[64:67], v247, s[8:11], s3 offen offset:0 sc1
  buffer_load_dwordx4 a[68:71], v247, s[8:11], s3 offen offset:1024 sc1
  buffer_load_dwordx4 a[72:75], v247, s[8:11], s3 offen offset:2048 sc1
  buffer_load_dwordx4 a[76:79], v247, s[8:11], s3 offen offset:3072 sc1
  s_add_u32 s3, s3, 4096
  buffer_load_dwordx4 a[80:83], v247, s[8:11], s3 offen offset:0 sc1
  buffer_load_dwordx4 a[84:87], v247, s[8:11], s3 offen offset:1024 sc1
  buffer_load_dwordx4 a[88:91], v247, s[8:11], s3 offen offset:2048 sc1
  buffer_load_dwordx4 a[92:95], v247, s[8:11], s3 offen offset:3072 sc1
  s_add_u32 s3, s3, 4096
  buffer_load_dwordx4 a[96:99], v247, s[8:11], s3 offen offset:0 sc1
  buffer_load_dwordx4 a[100:103], v247, s[8:11], s3 offen offset:1024 sc1
  buffer_load_dwordx4 a[104:107], v247, s[8:11], s3 offen offset:2048 sc1
  buffer_load_dwordx4 a[108:111], v247, s[8:11], s3 offen offset:3072 sc1
  s_add_u32 s3, s3, 4096
  buffer_load_dwordx4 a[112:115], v247, s[8:11], s3 offen offset:0 sc1
  buffer_load_dwordx4 a[116:119], v247, s[8:11], s3 offen offset:1024 sc1
  buffer_load_dwordx4 a[120:123], v247, s[8:11], s3 offen offset:2048 sc1
  buffer_load_dwordx4 a[124:127], v247, s[8:11], s3 offen offset:3072 sc1
  s_cmp_lg_u32 s28, 0
  s_cbranch_scc1 P2_join
  s_mov_b32 s81, 0
  s_branch P2_go
P2_loop:
  s_sleep 1
P2_go:
  buffer_load_dword v32, v56, s[8:11], 0 offen sc1
  buffer_load_dword v33, v57, s[8:11], 0 offen sc1
  buffer_load_dword v34, v58, s[8:11], 0 offen sc1
  buffer_load_dword v35, v59, s[8:11], 0 offen sc1
  s_add_u32 s81, s81, 1
  s_cmp_ge_u32 s81, 100000
  s_cbranch_scc1 P2_done
  s_waitcnt vmcnt(0)
  v_cmp_ne_u32 vcc, s29, v32
  v_cmp_ne_u32 s[82:83], s29, v33
  s_or_b64 vcc, vcc, s[82:83]
  v_cmp_ne_u32 s[82:83], s29, v34
  s_or_b64 vcc, vcc, s[82:83]
  v_cmp_ne_u32 s[82:83], s29, v35
  s_or_b64 vcc, vcc, s[82:83]
  s_cbranch_vccnz P2_loop
P2_done:
P2_join:
  s_barrier
  s_add_u32 m0, s72, 0
  s_add_u32 s86, s71, 0
  buffer_load_dwordx4 v241, s[12:15], s86 offen sc1 lds
  s_add_u32 m0, s72, 1024
  s_add_u32 s86, s71, 1024
  buffer_load_dwordx4 v241, s[12:15], s86 offen sc1 lds
  s_add_u32 m0, s72, 2048
  s_add_u32 s86, s71, 2048
  buffer_load_dwordx4 v241, s[12:15], s86 offen sc1 lds
  s_add_u32 m0, s72, 3072
  s_add_u32 s86, s71, 3072
  buffer_load_dwordx4 v241, s[12:15], s86 offen sc1 lds
  s_add_u32 m0, s72, 16384
  s_add_u32 s86, s71, 16384
  buffer_load_dwordx4 v241, s[12:15], s86 offen sc1 lds
  s_add_u32 m0, s72, 17408
  s_add_u32 s86, s71, 17408
  buffer_load_dwordx4 v241, s[12:15], s86 offen sc1 lds
  s_add_u32 m0, s72, 18432
  s_add_u32 s86, s71, 18432
  buffer_load_dwordx4 v241, s[12:15], s86 offen sc1 lds
  s_add_u32 m0, s72, 19456
  s_add_u32 s86, s71, 19456
  buffer_load_dwordx4 v241, s[12:15], s86 offen sc1 lds
  v_and_b32 v8, 31, v0
  v_lshlrev_b32 v8, 3, v8
  s_lshl_b32 s80, s32, 10
  s_lshl_b32 s81, s74, 9
  s_add_u32 s80, s80, s81
  s_add_u32 s80, s80, 14680064
  v_mov_b32 v9, 1073741824
  v_bfe_u32 v10, v0, 5, 1
  v_cmp_eq_u32 vcc, 0, v10
  s_nop 1
  v_cndmask_b32 v8, v9, v8, vcc
  buffer_load_dwordx2 v[24:25], v8, s[8:11], s80 offen sc1
  buffer_load_dwordx2 v[28:29], v8, s[8:11], s80 offen offset:256 sc1
  v_mov_b32 v26, 0
  v_mov_b32 v27, 0
  v_mov_b32 v30, 0
  v_mov_b32 v31, 0
  s_add_u32 m0, s72, 98304
  s_add_u32 s86, s71, 32768
  buffer_load_dwordx4 v241, s[12:15], s86 offen sc1 lds
  s_add_u32 m0, s72, 99328
  s_add_u32 s86, s71, 33792
  buffer_load_dwordx4 v241, s[12:15], s86 offen sc1 lds
  s_add_u32 m0, s72, 100352
  s_add_u32 s86, s71, 34816
  buffer_load_dwordx4 v241, s[12:15], s86 offen sc1 lds
  s_add_u32 m0, s72, 101376
  s_add_u32 s86, s71, 35840
  buffer_load_dwordx4 v241, s[12:15], s86 offen sc1 lds
  s_add_u32 m0, s72, 65536
  s_add_u32 s86, s71, 49152
  buffer_load_dwordx4 v241, s[12:15], s86 offen sc1 lds
  s_add_u32 m0, s72, 66560
  s_add_u32 s86, s71, 50176
  buffer_load_dwordx4 v241, s[12:15], s86 offen sc1 lds
  s_add_u32 m0, s72, 67584
  s_add_u32 s86, s71, 51200
  buffer_load_dwordx4 v241, s[12:15], s86 offen sc1 lds
  s_add_u32 m0, s72, 68608
  s_add_u32 s86, s71, 52224
  buffer_load_dwordx4 v241, s[12:15], s86 offen sc1 lds
  s_add_u32 m0, s72, 81920
  s_add_u32 s86, s71, 65536
  buffer_load_dwordx4 v241, s[12:15], s86 offen sc1 lds
  s_add_u32 m0, s72, 82944
  s_add_u32 s86, s71, 66560
  buffer_load_dwordx4 v241, s[12:15], s86 offen sc1 lds
  s_add_u32 m0, s72, 83968
  s_add_u32 s86, s71, 67584
  buffer_load_dwordx4 v241, s[12:15], s86 offen sc1 lds
  s_add_u32 m0, s72, 84992
  s_add_u32 s86, s71, 68608
  buffer_load_dwordx4 v241, s[12:15], s86 offen sc1 lds
  s_waitcnt vmcnt(18)
  s_barrier
  ds_read_b64_tr_b16 v[128:129], v16 offset:49152
  ds_read_b64_tr_b16 v[136:137], v6 offset:0
  ds_read_b64_tr_b16 v[130:131], v16 offset:51200
  ds_read_b64_tr_b16 v[138:139], v6 offset:2048
  ds_read_b64_tr_b16 v[132:133], v17 offset:49152
  ds_read_b64_tr_b16 v[140:141], v7 offset:0
  ds_read_b64_tr_b16 v[134:135], v17 offset:51200
  ds_read_b64_tr_b16 v[142:143], v7 offset:2048
  ds_read_b64_tr_b16 v[144:145], v16 offset:53248
  ds_read_b64_tr_b16 v[152:153], v6 offset:4096
  ds_read_b64_tr_b16 v[146:147], v16 offset:55296
  ds_read_b64_tr_b16 v[154:155], v6 offset:6144
  ds_read_b64_tr_b16 v[148:149], v17 offset:53248
  ds_read_b64_tr_b16 v[156:157], v7 offset:4096
  ds_read_b64_tr_b16 v[150:151], v17 offset:55296
  ds_read_b64_tr_b16 v[158:159], v7 offset:6144
  s_waitcnt lgkmcnt(8)
  v_mfma_f32_32x32x16_bf16 v[64:79], v[128:131], v[136:139], 0
  ds_read_b64_tr_b16 v[160:161], v16 offset:57344
  ds_read_b64_tr_b16 v[168:169], v6 offset:8192
  s_add_u32 s3, s3, 4096
  buffer_load_dwordx4 a[128:131], v247, s[8:11], s3 offen offset:0 sc1
  v_mfma_f32_32x32x16_bf16 v[80:95], v[128:131], v[140:143], 0
  ds_read_b64_tr_b16 v[162:163], v16 offset:59392
  ds_read_b64_tr_b16 v[170:171], v6 offset:10240
  v_mfma_f32_32x32x16_bf16 v[96:111], v[132:135], v[136:139], 0
  ds_read_b64_tr_b16 v[164:165], v17 offset:57344
  ds_read_b64_tr_b16 v[172:173], v7 offset:8192
  buffer_load_dwordx4 a[132:135], v247, s[8:11], s3 offen offset:1024 sc1
  v_mfma_f32_32x32x16_bf16 v[112:127], v[132:135], v[140:143], 0
  ds_read_b64_tr_b16 v[166:167], v17 offset:59392
  ds_read_b64_tr_b16 v[174:175], v7 offset:10240
  s_waitcnt lgkmcnt(8)
  v_mfma_f32_32x32x16_bf16 v[64:79], v[144:147], v[152:155], v[64:79]
  ds_read_b64_tr_b16 v[128:129], v16 offset:61440
  ds_read_b64_tr_b16 v[136:137], v6 offset:12288
  buffer_load_dwordx4 a[136:139], v247, s[8:11], s3 offen offset:2048 sc1
  v_mfma_f32_32x32x16_bf16 v[80:95], v[144:147], v[156:159], v[80:95]
  ds_read_b64_tr_b16 v[130:131], v16 offset:63488
  ds_read_b64_tr_b16 v[138:139], v6 offset:14336
  v_mfma_f32_32x32x16_bf16 v[96:111], v[148:151], v[152:155], v[96:111]
  ds_read_b64_tr_b16 v[132:133], v17 offset:61440
  ds_read_b64_tr_b16 v[140:141], v7 offset:12288
  buffer_load_dwordx4 a[140:143], v247, s[8:11], s3 offen offset:3072 sc1
  v_mfma_f32_32x32x16_bf16 v[112:127], v[148:151], v[156:159], v[112:127]
  ds_read_b64_tr_b16 v[134:135], v17 offset:63488
  ds_read_b64_tr_b16 v[142:143], v7 offset:14336
  s_waitcnt lgkmcnt(8)
  s_waitcnt vmcnt(18)
  s_barrier
  v_mfma_f32_32x32x16_bf16 v[64:79], v[160:163], v[168:171], v[64:79]
  ds_read_b64_tr_b16 v[144:145], v18 offset:0
  ds_read_b64_tr_b16 v[152:153], v6 offset:16384
  v_mfma_f32_32x32x16_bf16 v[80:95], v[160:163], v[172:175], v[80:95]
  ds_read_b64_tr_b16 v[146:147], v18 offset:2048
  ds_read_b64_tr_b16 v[154:155], v6 offset:18432
  v_mfma_f32_32x32x16_bf16 v[96:111], v[164:167], v[168:171], v[96:111]
  ds_read_b64_tr_b16 v[148:149], v19 offset:0
  ds_read_b64_tr_b16 v[156:157], v7 offset:16384
  v_mfma_f32_32x32x16_bf16 v[112:127], v[164:167], v[172:175], v[112:127]
  ds_read_b64_tr_b16 v[150:151], v19 offset:2048
  ds_read_b64_tr_b16 v[158:159], v7 offset:18432
  s_waitcnt lgkmcnt(8)
  v_mfma_f32_32x32x16_bf16 v[64:79], v[128:131], v[136:139], v[64:79]
  ds_read_b64_tr_b16 v[160:161], v18 offset:4096
  ds_read_b64_tr_b16 v[168:169], v6 offset:20480
  v_mfma_f32_32x32x16_bf16 v[80:95], v[128:131], v[140:143], v[80:95]
  ds_read_b64_tr_b16 v[162:163], v18 offset:6144
  ds_read_b64_tr_b16 v[170:171], v6 offset:22528
  v_mfma_f32_32x32x16_bf16 v[96:111], v[132:135], v[136:139], v[96:111]
  ds_read_b64_tr_b16 v[164:165], v19 offset:4096
  ds_read_b64_tr_b16 v[172:173], v7 offset:20480
  v_mfma_f32_32x32x16_bf16 v[112:127], v[132:135], v[140:143], v[112:127]
  ds_read_b64_tr_b16 v[166:167], v19 offset:6144
  ds_read_b64_tr_b16 v[174:175], v7 offset:22528
  s_waitcnt lgkmcnt(8)
  v_mfma_f32_32x32x16_bf16 v[64:79], v[144:147], v[152:155], v[64:79]
  ds_read_b64_tr_b16 v[128:129], v18 offset:8192
  ds_read_b64_tr_b16 v[136:137], v6 offset:24576
  s_add_u32 s3, s3, 4096
  buffer_load_dwordx4 a[144:147], v247, s[8:11], s3 offen offset:0 sc1
  v_mfma_f32_32x32x16_bf16 v[80:95], v[144:147], v[156:159], v[80:95]
  ds_read_b64_tr_b16 v[130:131], v18 offset:10240
  ds_read_b64_tr_b16 v[138:139], v6 offset:26624
  v_mfma_f32_32x32x16_bf16 v[96:111], v[148:151], v[152:155], v[96:111]
  ds_read_b64_tr_b16 v[132:133], v19 offset:8192
  ds_read_b64_tr_b16 v[140:141], v7 offset:24576
  buffer_load_dwordx4 a[148:151], v247, s[8:11], s3 offen offset:1024 sc1
  v_mfma_f32_32x32x16_bf16 v[112:127], v[148:151], v[156:159], v[112:127]
  ds_read_b64_tr_b16 v[134:135], v19 offset:10240
  ds_read_b64_tr_b16 v[142:143], v7 offset:26624
  s_waitcnt lgkmcnt(8)
  v_mfma_f32_32x32x16_bf16 v[64:79], v[160:163], v[168:171], v[64:79]
  ds_read_b64_tr_b16 v[144:145], v18 offset:12288
  ds_read_b64_tr_b16 v[152:153], v6 offset:28672
  buffer_load_dwordx4 a[152:155], v247, s[8:11], s3 offen offset:2048 sc1
  v_mfma_f32_32x32x16_bf16 v[80:95], v[160:163], v[172:175], v[80:95]
  ds_read_b64_tr_b16 v[146:147], v18 offset:14336
  ds_read_b64_tr_b16 v[154:155], v6 offset:30720
  v_mfma_f32_32x32x16_bf16 v[96:111], v[164:167], v[168:171], v[96:111]
  ds_read_b64_tr_b16 v[148:149], v19 offset:12288
  ds_read_b64_tr_b16 v[156:157], v7 offset:28672
  buffer_load_dwordx4 a[156:159], v247, s[8:11], s3 offen offset:3072 sc1
  v_mfma_f32_32x32x16_bf16 v[112:127], v[164:167], v[172:175], v[112:127]
  ds_read_b64_tr_b16 v[150:151], v19 offset:14336
  ds_read_b64_tr_b16 v[158:159], v7 offset:30720
  s_waitcnt lgkmcnt(8)
  s_waitcnt vmcnt(16)
  s_barrier
  v_mfma_f32_32x32x16_bf16 v[64:79], v[128:131], v[136:139], v[64:79]
  ds_read_b64_tr_b16 v[160:161], v18 offset:16384
  ds_read_b64_tr_b16 v[168:169], v20 offset:32768
  s_add_u32 m0, s72, 0
  s_add_u32 s86, s71, 81920
  buffer_load_dwordx4 v241, s[12:15], s86 offen sc1 lds
  v_mfma_f32_32x32x16_bf16 v[80:95], v[128:131], v[140:143], v[80:95]
  ds_read_b64_tr_b16 v[162:163], v18 offset:18432
  ds_read_b64_tr_b16 v[170:171], v20 offset:34816
  s_add_u32 m0, s72, 1024
  s_add_u32 s86, s71, 82944
  buffer_load_dwordx4 v241, s[12:15], s86 offen sc1 lds
  v_mfma_f32_32x32x16_bf16 v[96:111], v[132:135], v[136:139], v[96:111]
  ds_read_b64_tr_b16 v[164:165], v19 offset:16384
  ds_read_b64_tr_b16 v[172:173], v21 offset:32768
  s_add_u32 m0, s72, 2048
  s_add_u32 s86, s71, 83968
  buffer_load_dwordx4 v241, s[12:15], s86 offen sc1 lds
  v_mfma_f32_32x32x16_bf16 v[112:127], v[132:135], v[140:143], v[112:127]
  ds_read_b64_tr_b16 v[166:167], v19 offset:18432
  ds_read_b64_tr_b16 v[174:175], v21 offset:34816
  s_add_u32 m0, s72, 3072
  s_add_u32 s86, s71, 84992
  buffer_load_dwordx4 v241, s[12:15], s86 offen sc1 lds
  s_waitcnt lgkmcnt(8)
  v_mfma_f32_32x32x16_bf16 v[64:79], v[144:147], v[152:155], v[64:79]
  ds_read_b64_tr_b16 v[128:129], v18 offset:20480
  ds_read_b64_tr_b16 v[136:137], v20 offset:36864
  s_add_u32 m0, s72, 114688
  s_add_u32 s86, s70, 1146880
  buffer_load_dwordx4 v240, s[20:23], s86 offen lds
  v_mfma_f32_32x32x16_bf16 v[80:95], v[144:147], v[156:159], v[80:95]
  ds_read_b64_tr_b16 v[130:131], v18 offset:22528
  ds_read_b64_tr_b16 v[138:139], v20 offset:38912
  s_add_u32 m0, s72, 115712
  s_add_u32 s86, s70, 1161216
  buffer_load_dwordx4 v240, s[20:23], s86 offen lds
  v_mfma_f32_32x32x16_bf16 v[96:111], v[148:151], v[152:155], v[96:111]
  ds_read_b64_tr_b16 v[132:133], v19 offset:20480
  ds_read_b64_tr_b16 v[140:141], v21 offset:36864
  s_add_u32 m0, s72, 116736
  s_add_u32 s86, s70, 1175552
  buffer_load_dwordx4 v240, s[20:23], s86 offen lds
  v_mfma_f32_32x32x16_bf16 v[112:127], v[148:151], v[156:159], v[112:127]
  ds_read_b64_tr_b16 v[134:135], v19 offset:22528
  ds_read_b64_tr_b16 v[142:143], v21 offset:38912
  s_add_u32 m0, s72, 117760
  s_add_u32 s86, s70, 1189888
  buffer_load_dwordx4 v240, s[20:23], s86 offen lds
  s_waitcnt lgkmcnt(8)
  v_mfma_f32_32x32x16_bf16 v[64:79], v[160:163], v[168:171], v[64:79]
  ds_read_b64_tr_b16 v[144:145], v18 offset:24576
  ds_read_b64_tr_b16 v[152:153], v20 offset:40960
  s_add_u32 s3, s3, 4096
  buffer_load_dwordx4 a[160:163], v247, s[8:11], s3 offen offset:0 sc1
  v_mfma_f32_32x32x16_bf16 v[80:95], v[160:163], v[172:175], v[80:95]
  ds_read_b64_tr_b16 v[146:147], v18 offset:26624
  ds_read_b64_tr_b16 v[154:155], v20 offset:43008
  v_mfma_f32_32x32x16_bf16 v[96:111], v[164:167], v[168:171], v[96:111]
  ds_read_b64_tr_b16 v[148:149], v19 offset:24576
  ds_read_b64_tr_b16 v[156:157], v21 offset:40960
  buffer_load_dwordx4 a[164:167], v247, s[8:11], s3 offen offset:1024 sc1
  v_mfma_f32_32x32x16_bf16 v[112:127], v[164:167], v[172:175], v[112:127]
  ds_read_b64_tr_b16 v[150:151], v19 offset:26624
  ds_read_b64_tr_b16 v[158:159], v21 offset:43008
  s_waitcnt lgkmcnt(8)
  v_mfma_f32_32x32x16_bf16 v[64:79], v[128:131], v[136:139], v[64:79]
  ds_read_b64_tr_b16 v[160:161], v18 offset:28672
  ds_read_b64_tr_b16 v[168:169], v20 offset:45056
  buffer_load_dwordx4 a[168:171], v247, s[8:11], s3 offen offset:2048 sc1
  v_mfma_f32_32x32x16_bf16 v[80:95], v[128:131], v[140:143], v[80:95]
  ds_read_b64_tr_b16 v[162:163], v18 offset:30720
  ds_read_b64_tr_b16 v[170:171], v20 offset:47104
  v_mfma_f32_32x32x16_bf16 v[96:111], v[132:135], v[136:139], v[96:111]
  ds_read_b64_tr_b16 v[164:165], v19 offset:28672
  ds_read_b64_tr_b16 v[172:173], v21 offset:45056
  buffer_load_dwordx4 a[172:175], v247, s[8:11], s3 offen offset:3072 sc1
  v_mfma_f32_32x32x16_bf16 v[112:127], v[132:135], v[140:143], v[112:127]
  ds_read_b64_tr_b16 v[166:167], v19 offset:30720
  ds_read_b64_tr_b16 v[174:175], v21 offset:47104
  s_waitcnt lgkmcnt(8)
  s_waitcnt vmcnt(24)
  s_barrier
  v_mfma_f32_32x32x16_bf16 v[64:79], v[144:147], v[152:155], v[64:79]
  ds_read_b64_tr_b16 v[128:129], v4 offset:32768
  ds_read_b64_tr_b16 v[136:137], v20 offset:0
  s_add_u32 m0, s72, 16384
  s_add_u32 s86, s71, 98304
  buffer_load_dwordx4 v241, s[12:15], s86 offen sc1 lds
  v_mfma_f32_32x32x16_bf16 v[80:95], v[144:147], v[156:159], v[80:95]
  ds_read_b64_tr_b16 v[130:131], v4 offset:34816
  ds_read_b64_tr_b16 v[138:139], v20 offset:2048
  s_add_u32 m0, s72, 17408
  s_add_u32 s86, s71, 99328
  buffer_load_dwordx4 v241, s[12:15], s86 offen sc1 lds
  v_mfma_f32_32x32x16_bf16 v[96:111], v[148:151], v[152:155], v[96:111]
  ds_read_b64_tr_b16 v[132:133], v5 offset:32768
  ds_read_b64_tr_b16 v[140:141], v21 offset:0
  s_add_u32 m0, s72, 18432
  s_add_u32 s86, s71, 100352
  buffer_load_dwordx4 v241, s[12:15], s86 offen sc1 lds
  v_mfma_f32_32x32x16_bf16 v[112:127], v[148:151], v[156:159], v[112:127]
  ds_read_b64_tr_b16 v[134:135], v5 offset:34816
  ds_read_b64_tr_b16 v[142:143], v21 offset:2048
  s_add_u32 m0, s72, 19456
  s_add_u32 s86, s71, 101376
  buffer_load_dwordx4 v241, s[12:15], s86 offen sc1 lds
  s_waitcnt lgkmcnt(8)
  v_mfma_f32_32x32x16_bf16 v[64:79], v[160:163], v[168:171], v[64:79]
  ds_read_b64_tr_b16 v[144:145], v4 offset:36864
  ds_read_b64_tr_b16 v[152:153], v20 offset:4096
  s_add_u32 m0, s72, 131072
  s_add_u32 s86, s70, 1376256
  buffer_load_dwordx4 v240, s[20:23], s86 offen lds
  v_mfma_f32_32x32x16_bf16 v[80:95], v[160:163], v[172:175], v[80:95]
  ds_read_b64_tr_b16 v[146:147], v4 offset:38912
  ds_read_b64_tr_b16 v[154:155], v20 offset:6144
  s_add_u32 m0, s72, 132096
  s_add_u32 s86, s70, 1390592
  buffer_load_dwordx4 v240, s[20:23], s86 offen lds
  v_mfma_f32_32x32x16_bf16 v[96:111], v[164:167], v[168:171], v[96:111]
  ds_read_b64_tr_b16 v[148:149], v5 offset:36864
  ds_read_b64_tr_b16 v[156:157], v21 offset:4096
  s_add_u32 m0, s72, 133120
  s_add_u32 s86, s70, 1404928
  buffer_load_dwordx4 v240, s[20:23], s86 offen lds
  v_mfma_f32_32x32x16_bf16 v[112:127], v[164:167], v[172:175], v[112:127]
  ds_read_b64_tr_b16 v[150:151], v5 offset:38912
  ds_read_b64_tr_b16 v[158:159], v21 offset:6144
  s_add_u32 m0, s72, 134144
  s_add_u32 s86, s70, 1419264
  buffer_load_dwordx4 v240, s[20:23], s86 offen lds
  s_waitcnt lgkmcnt(8)
  v_mfma_f32_32x32x16_bf16 v[64:79], v[128:131], v[136:139], v[64:79]
  ds_read_b64_tr_b16 v[160:161], v4 offset:40960
  ds_read_b64_tr_b16 v[168:169], v20 offset:8192
  s_add_u32 s3, s3, 4096
  buffer_load_dwordx4 a[176:179], v247, s[8:11], s3 offen offset:0 sc1
  v_mfma_f32_32x32x16_bf16 v[80:95], v[128:131], v[140:143], v[80:95]
  ds_read_b64_tr_b16 v[162:163], v4 offset:43008
  ds_read_b64_tr_b16 v[170:171], v20 offset:10240
  v_mfma_f32_32x32x16_bf16 v[96:111], v[132:135], v[136:139], v[96:111]
  ds_read_b64_tr_b16 v[164:165], v5 offset:40960
  ds_read_b64_tr_b16 v[172:173], v21 offset:8192
  buffer_load_dwordx4 a[180:183], v247, s[8:11], s3 offen offset:1024 sc1
  v_mfma_f32_32x32x16_bf16 v[112:127], v[132:135], v[140:143], v[112:127]
  ds_read_b64_tr_b16 v[166:167], v5 offset:43008
  ds_read_b64_tr_b16 v[174:175], v21 offset:10240
  s_waitcnt lgkmcnt(8)
  v_mfma_f32_32x32x16_bf16 v[64:79], v[144:147], v[152:155], v[64:79]
  ds_read_b64_tr_b16 v[128:129], v4 offset:45056
  ds_read_b64_tr_b16 v[136:137], v20 offset:12288
  buffer_load_dwordx4 a[184:187], v247, s[8:11], s3 offen offset:2048 sc1
  v_mfma_f32_32x32x16_bf16 v[80:95], v[144:147], v[156:159], v[80:95]
  ds_read_b64_tr_b16 v[130:131], v4 offset:47104
  ds_read_b64_tr_b16 v[138:139], v20 offset:14336
  v_mfma_f32_32x32x16_bf16 v[96:111], v[148:151], v[152:155], v[96:111]
  ds_read_b64_tr_b16 v[132:133], v5 offset:45056
  ds_read_b64_tr_b16 v[140:141], v21 offset:12288
  buffer_load_dwordx4 a[188:191], v247, s[8:11], s3 offen offset:3072 sc1
  v_mfma_f32_32x32x16_bf16 v[112:127], v[148:151], v[156:159], v[112:127]
  ds_read_b64_tr_b16 v[134:135], v5 offset:47104
  ds_read_b64_tr_b16 v[142:143], v21 offset:14336
  s_waitcnt lgkmcnt(8)
  s_waitcnt vmcnt(32)
  s_barrier
  v_mfma_f32_32x32x16_bf16 v[64:79], v[160:163], v[168:171], v[64:79]
  ds_read_b64_tr_b16 v[144:145], v4 offset:49152
  ds_read_b64_tr_b16 v[152:153], v20 offset:16384
  v_mfma_f32_32x32x16_bf16 v[80:95], v[160:163], v[172:175], v[80:95]
  ds_read_b64_tr_b16 v[146:147], v4 offset:51200
  ds_read_b64_tr_b16 v[154:155], v20 offset:18432
  v_mfma_f32_32x32x16_bf16 v[96:111], v[164:167], v[168:171], v[96:111]
  ds_read_b64_tr_b16 v[148:149], v5 offset:49152
  ds_read_b64_tr_b16 v[156:157], v21 offset:16384
  v_mfma_f32_32x32x16_bf16 v[112:127], v[164:167], v[172:175], v[112:127]
  ds_read_b64_tr_b16 v[150:151], v5 offset:51200
  ds_read_b64_tr_b16 v[158:159], v21 offset:18432
  s_waitcnt lgkmcnt(8)
  v_mfma_f32_32x32x16_bf16 v[64:79], v[128:131], v[136:139], v[64:79]
  ds_read_b64_tr_b16 v[160:161], v4 offset:53248
  ds_read_b64_tr_b16 v[168:169], v20 offset:20480
  v_mfma_f32_32x32x16_bf16 v[80:95], v[128:131], v[140:143], v[80:95]
  ds_read_b64_tr_b16 v[162:163], v4 offset:55296
  ds_read_b64_tr_b16 v[170:171], v20 offset:22528
  v_mfma_f32_32x32x16_bf16 v[96:111], v[132:135], v[136:139], v[96:111]
  ds_read_b64_tr_b16 v[164:165], v5 offset:53248
  ds_read_b64_tr_b16 v[172:173], v21 offset:20480
  v_mfma_f32_32x32x16_bf16 v[112:127], v[132:135], v[140:143], v[112:127]
  ds_read_b64_tr_b16 v[166:167], v5 offset:55296
  ds_read_b64_tr_b16 v[174:175], v21 offset:22528
  s_waitcnt lgkmcnt(8)
  v_mfma_f32_32x32x16_bf16 v[64:79], v[144:147], v[152:155], v[64:79]
  ds_read_b64_tr_b16 v[128:129], v4 offset:57344
  ds_read_b64_tr_b16 v[136:137], v20 offset:24576
  s_add_u32 s3, s3, 4096
  buffer_load_dwordx4 a[192:195], v247, s[8:11], s3 offen offset:0 sc1
  v_mfma_f32_32x32x16_bf16 v[80:95], v[144:147], v[156:159], v[80:95]
  ds_read_b64_tr_b16 v[130:131], v4 offset:59392
  ds_read_b64_tr_b16 v[138:139], v20 offset:26624
  v_mfma_f32_32x32x16_bf16 v[96:111], v[148:151], v[152:155], v[96:111]
  ds_read_b64_tr_b16 v[132:133], v5 offset:57344
  ds_read_b64_tr_b16 v[140:141], v21 offset:24576
  buffer_load_dwordx4 a[196:199], v247, s[8:11], s3 offen offset:1024 sc1
  v_mfma_f32_32x32x16_bf16 v[112:127], v[148:151], v[156:159], v[112:127]
  ds_read_b64_tr_b16 v[134:135], v5 offset:59392
  ds_read_b64_tr_b16 v[142:143], v21 offset:26624
  s_waitcnt lgkmcnt(8)
  v_mfma_f32_32x32x16_bf16 v[64:79], v[160:163], v[168:171], v[64:79]
  ds_read_b64_tr_b16 v[144:145], v4 offset:61440
  ds_read_b64_tr_b16 v[152:153], v20 offset:28672
  buffer_load_dwordx4 a[200:203], v247, s[8:11], s3 offen offset:2048 sc1
  v_mfma_f32_32x32x16_bf16 v[80:95], v[160:163], v[172:175], v[80:95]
  ds_read_b64_tr_b16 v[146:147], v4 offset:63488
  ds_read_b64_tr_b16 v[154:155], v20 offset:30720
  v_mfma_f32_32x32x16_bf16 v[96:111], v[164:167], v[168:171], v[96:111]
  ds_read_b64_tr_b16 v[148:149], v5 offset:61440
  ds_read_b64_tr_b16 v[156:157], v21 offset:28672
  buffer_load_dwordx4 a[204:207], v247, s[8:11], s3 offen offset:3072 sc1
  v_mfma_f32_32x32x16_bf16 v[112:127], v[164:167], v[172:175], v[112:127]
  ds_read_b64_tr_b16 v[150:151], v5 offset:63488
  ds_read_b64_tr_b16 v[158:159], v21 offset:30720
  s_waitcnt lgkmcnt(8)
  s_waitcnt vmcnt(20)
  s_barrier
  v_mfma_f32_32x32x16_bf16 v[64:79], v[128:131], v[136:139], v[64:79]
  ds_read_b64_tr_b16 v[160:161], v16 offset:49152
  ds_read_b64_tr_b16 v[168:169], v6 offset:0
  v_mfma_f32_32x32x16_bf16 v[80:95], v[128:131], v[140:143], v[80:95]
  ds_read_b64_tr_b16 v[162:163], v16 offset:51200
  ds_read_b64_tr_b16 v[170:171], v6 offset:2048
  v_mfma_f32_32x32x16_bf16 v[96:111], v[132:135], v[136:139], v[96:111]
  ds_read_b64_tr_b16 v[164:165], v17 offset:49152
  ds_read_b64_tr_b16 v[172:173], v7 offset:0
  v_mfma_f32_32x32x16_bf16 v[112:127], v[132:135], v[140:143], v[112:127]
  ds_read_b64_tr_b16 v[166:167], v17 offset:51200
  ds_read_b64_tr_b16 v[174:175], v7 offset:2048
  s_waitcnt lgkmcnt(8)
  v_mfma_f32_32x32x16_bf16 v[64:79], v[144:147], v[152:155], v[64:79]
  ds_read_b64_tr_b16 v[128:129], v16 offset:53248
  ds_read_b64_tr_b16 v[136:137], v6 offset:4096
  v_mfma_f32_32x32x16_bf16 v[80:95], v[144:147], v[156:159], v[80:95]
  ds_read_b64_tr_b16 v[130:131], v16 offset:55296
  ds_read_b64_tr_b16 v[138:139], v6 offset:6144
  v_mfma_f32_32x32x16_bf16 v[96:111], v[148:151], v[152:155], v[96:111]
  ds_read_b64_tr_b16 v[132:133], v17 offset:53248
  ds_read_b64_tr_b16 v[140:141], v7 offset:4096
  v_mfma_f32_32x32x16_bf16 v[112:127], v[148:151], v[156:159], v[112:127]
  ds_read_b64_tr_b16 v[134:135], v17 offset:55296
  ds_read_b64_tr_b16 v[142:143], v7 offset:6144
  s_waitcnt lgkmcnt(8)
  v_mfma_f32_32x32x16_bf16 v[64:79], v[160:163], v[168:171], v[64:79]
  ds_read_b64_tr_b16 v[144:145], v16 offset:57344
  ds_read_b64_tr_b16 v[152:153], v6 offset:8192
  s_add_u32 s3, s3, 4096
  buffer_load_dwordx4 a[208:211], v247, s[8:11], s3 offen offset:0 sc1
  v_mfma_f32_32x32x16_bf16 v[80:95], v[160:163], v[172:175], v[80:95]
  ds_read_b64_tr_b16 v[146:147], v16 offset:59392
  ds_read_b64_tr_b16 v[154:155], v6 offset:10240
  v_mfma_f32_32x32x16_bf16 v[96:111], v[164:167], v[168:171], v[96:111]
  ds_read_b64_tr_b16 v[148:149], v17 offset:57344
  ds_read_b64_tr_b16 v[156:157], v7 offset:8192
  buffer_load_dwordx4 a[212:215], v247, s[8:11], s3 offen offset:1024 sc1
  v_mfma_f32_32x32x16_bf16 v[112:127], v[164:167], v[172:175], v[112:127]
  ds_read_b64_tr_b16 v[150:151], v17 offset:59392
  ds_read_b64_tr_b16 v[158:159], v7 offset:10240
  s_waitcnt lgkmcnt(8)
  v_mfma_f32_32x32x16_bf16 v[64:79], v[128:131], v[136:139], v[64:79]
  ds_read_b64_tr_b16 v[160:161], v16 offset:61440
  ds_read_b64_tr_b16 v[168:169], v6 offset:12288
  buffer_load_dwordx4 a[216:219], v247, s[8:11], s3 offen offset:2048 sc1
  v_mfma_f32_32x32x16_bf16 v[80:95], v[128:131], v[140:143], v[80:95]
  ds_read_b64_tr_b16 v[162:163], v16 offset:63488
  ds_read_b64_tr_b16 v[170:171], v6 offset:14336
  v_mfma_f32_32x32x16_bf16 v[96:111], v[132:135], v[136:139], v[96:111]
  ds_read_b64_tr_b16 v[164:165], v17 offset:61440
  ds_read_b64_tr_b16 v[172:173], v7 offset:12288
  buffer_load_dwordx4 a[220:223], v247, s[8:11], s3 offen offset:3072 sc1
  v_mfma_f32_32x32x16_bf16 v[112:127], v[132:135], v[140:143], v[112:127]
  ds_read_b64_tr_b16 v[166:167], v17 offset:63488
  ds_read_b64_tr_b16 v[174:175], v7 offset:14336
  s_waitcnt lgkmcnt(8)
  s_waitcnt vmcnt(12)
  s_barrier
  v_mfma_f32_32x32x16_bf16 v[64:79], v[144:147], v[152:155], v[64:79]
  ds_read_b64_tr_b16 v[128:129], v18 offset:0
  ds_read_b64_tr_b16 v[136:137], v6 offset:16384
  v_mfma_f32_32x32x16_bf16 v[80:95], v[144:147], v[156:159], v[80:95]
  ds_read_b64_tr_b16 v[130:131], v18 offset:2048
  ds_read_b64_tr_b16 v[138:139], v6 offset:18432
  v_mfma_f32_32x32x16_bf16 v[96:111], v[148:151], v[152:155], v[96:111]
  ds_read_b64_tr_b16 v[132:133], v19 offset:0
  ds_read_b64_tr_b16 v[140:141], v7 offset:16384
  v_mfma_f32_32x32x16_bf16 v[112:127], v[148:151], v[156:159], v[112:127]
  ds_read_b64_tr_b16 v[134:135], v19 offset:2048
  ds_read_b64_tr_b16 v[142:143], v7 offset:18432
  s_waitcnt lgkmcnt(8)
  v_mfma_f32_32x32x16_bf16 v[64:79], v[160:163], v[168:171], v[64:79]
  ds_read_b64_tr_b16 v[144:145], v18 offset:4096
  ds_read_b64_tr_b16 v[152:153], v6 offset:20480
  v_mfma_f32_32x32x16_bf16 v[80:95], v[160:163], v[172:175], v[80:95]
  ds_read_b64_tr_b16 v[146:147], v18 offset:6144
  ds_read_b64_tr_b16 v[154:155], v6 offset:22528
  v_mfma_f32_32x32x16_bf16 v[96:111], v[164:167], v[168:171], v[96:111]
  ds_read_b64_tr_b16 v[148:149], v19 offset:4096
  ds_read_b64_tr_b16 v[156:157], v7 offset:20480
  v_mfma_f32_32x32x16_bf16 v[112:127], v[164:167], v[172:175], v[112:127]
  ds_read_b64_tr_b16 v[150:151], v19 offset:6144
  ds_read_b64_tr_b16 v[158:159], v7 offset:22528
  s_waitcnt lgkmcnt(8)
  v_mfma_f32_32x32x16_bf16 v[64:79], v[128:131], v[136:139], v[64:79]
  ds_read_b64_tr_b16 v[160:161], v18 offset:8192
  ds_read_b64_tr_b16 v[168:169], v6 offset:24576
  v_mfma_f32_32x32x16_bf16 v[80:95], v[128:131], v[140:143], v[80:95]
  ds_read_b64_tr_b16 v[162:163], v18 offset:10240
  ds_read_b64_tr_b16 v[170:171], v6 offset:26624
  v_mfma_f32_32x32x16_bf16 v[96:111], v[132:135], v[136:139], v[96:111]
  ds_read_b64_tr_b16 v[164:165], v19 offset:8192
  ds_read_b64_tr_b16 v[172:173], v7 offset:24576
  v_mfma_f32_32x32x16_bf16 v[112:127], v[132:135], v[140:143], v[112:127]
  ds_read_b64_tr_b16 v[166:167], v19 offset:10240
  ds_read_b64_tr_b16 v[174:175], v7 offset:26624
  s_waitcnt lgkmcnt(8)
  v_mfma_f32_32x32x16_bf16 v[64:79], v[144:147], v[152:155], v[64:79]
  ds_read_b64_tr_b16 v[128:129], v18 offset:12288
  ds_read_b64_tr_b16 v[136:137], v6 offset:28672
  v_and_b32 v11, 31, v0
  v_lshlrev_b32 v11, 3, v11
  s_lshl_b32 s79, s31, 1
  s_add_u32 s79, s79, s73
  s_lshl_b32 s79, s79, 9
  s_add_u32 s79, s79, 15860736
  s_lshl_b32 s80, s74, 8
  v_add_u32 v10, s80, v11
  s_xor_b32 s80, s80, 256
  v_add_u32 v11, s80, v11
  v_mfma_f32_32x32x16_bf16 v[80:95], v[144:147], v[156:159], v[80:95]
  ds_read_b64_tr_b16 v[130:131], v18 offset:14336
  ds_read_b64_tr_b16 v[138:139], v6 offset:30720
  v_mfma_f32_32x32x16_bf16 v[96:111], v[148:151], v[152:155], v[96:111]
  ds_read_b64_tr_b16 v[132:133], v19 offset:12288
  ds_read_b64_tr_b16 v[140:141], v7 offset:28672
  buffer_load_dwordx2 v[12:13], v10, s[8:11], s79 offen sc1
  v_mfma_f32_32x32x16_bf16 v[112:127], v[148:151], v[156:159], v[112:127]
  ds_read_b64_tr_b16 v[134:135], v19 offset:14336
  ds_read_b64_tr_b16 v[142:143], v7 offset:30720
  buffer_load_dwordx2 v[14:15], v11, s[8:11], s79 offen sc1
  s_waitcnt lgkmcnt(8)
  v_mfma_f32_32x32x16_bf16 v[64:79], v[160:163], v[168:171], v[64:79]
  v_mfma_f32_32x32x16_bf16 v[80:95], v[160:163], v[172:175], v[80:95]
  v_mfma_f32_32x32x16_bf16 v[96:111], v[164:167], v[168:171], v[96:111]
  v_mfma_f32_32x32x16_bf16 v[112:127], v[164:167], v[172:175], v[112:127]
  s_waitcnt lgkmcnt(0)
  v_mfma_f32_32x32x16_bf16 v[64:79], v[128:131], v[136:139], v[64:79]
  v_mfma_f32_32x32x16_bf16 v[80:95], v[128:131], v[140:143], v[80:95]
  v_mfma_f32_32x32x16_bf16 v[96:111], v[132:135], v[136:139], v[96:111]
  v_mfma_f32_32x32x16_bf16 v[112:127], v[132:135], v[140:143], v[112:127]
  v_and_b32 v1, 63, v0
  v_lshlrev_b32 v1, 4, v1
  s_lshl_b32 s80, s31, 1
  s_add_u32 s80, s80, s73
  s_mul_i32 s80, s80, 229376
  s_lshl_b32 s81, s32, 14
  s_add_u32 s80, s80, s81
  s_lshl_b32 s81, s74, 13
  s_add_u32 s80, s80, s81
  s_lshl_b32 s81, s74, 10
  s_add_u32 s85, s80, s81
  s_xor_b32 s81, s81, 1024
  s_add_u32 s87, s80, s81
  s_mov_b32 s88, 0
HR_loop:
  s_waitcnt vmcnt(0)
  v_cmp_ne_u32 vcc, s29, v13
  v_cmp_ne_u32 s[82:83], s29, v15
  s_or_b64 vcc, vcc, s[82:83]
  s_cbranch_vccz HR_done
  s_add_u32 s88, s88, 1
  s_cmp_ge_u32 s88, 100000
  s_cbranch_scc1 HR_done
  buffer_load_dwordx2 v[12:13], v10, s[8:11], s79 offen sc1
  buffer_load_dwordx2 v[14:15], v11, s[8:11], s79 offen sc1
  s_branch HR_loop
HR_done:
  v_and_b32 v8, s91, v12
  v_lshlrev_b32 v16, 16, v12
  v_and_b32 v9, s91, v14
  v_lshlrev_b32 v17, 16, v14
  v_rcp_f32 v18, v8
  v_rcp_f32 v19, v9
  s_mov_b32 s82, 0x07060302
  s_mov_b32 s83, 0x80008000
  v_perm_b32 v32, v16, v16, s82
  v_xor_b32 v32, s83, v32
  v_lshrrev_b32 v33, 16, v32
  v_mov_b32 v34, 0
  v_mov_b32 v35, 0
  v_perm_b32 v36, v17, v17, s82
  v_xor_b32 v36, s83, v36
  v_lshrrev_b32 v37, 16, v36
  v_mov_b32 v38, 0
  v_mov_b32 v39, 0
  s_mov_b32 s82, 0xbfb8aa3b
  v_mfma_f32_32x32x16_bf16 v[64:79], v[24:27], v[32:35], v[64:79]
  v_mfma_f32_32x32x16_bf16 v[80:95], v[24:27], v[36:39], v[80:95]
  v_mfma_f32_32x32x16_bf16 v[96:111], v[28:31], v[32:35], v[96:111]
  v_mfma_f32_32x32x16_bf16 v[112:127], v[28:31], v[36:39], v[112:127]
  v_mul_f32 v22, s82, v18
  v_mul_f32 v23, s82, v19
  s_nop 6
  v_pk_mul_f32 v[40:41], v[64:65], v[22:23] op_sel_hi:[1,0]
  v_pk_mul_f32 v[42:43], v[66:67], v[22:23] op_sel_hi:[1,0]
  v_pk_mul_f32 v[44:45], v[68:69], v[22:23] op_sel_hi:[1,0]
  v_pk_mul_f32 v[46:47], v[70:71], v[22:23] op_sel_hi:[1,0]
  v_exp_f32 v40, v40
  v_exp_f32 v41, v41
  v_exp_f32 v42, v42
  v_exp_f32 v43, v43
  v_exp_f32 v44, v44
  v_exp_f32 v45, v45
  v_exp_f32 v46, v46
  v_exp_f32 v47, v47
  v_pk_fma_f32 v[40:41], v[40:41], v[8:9], v[8:9] op_sel_hi:[1,0,0]
  v_pk_fma_f32 v[42:43], v[42:43], v[8:9], v[8:9] op_sel_hi:[1,0,0]
  v_pk_fma_f32 v[44:45], v[44:45], v[8:9], v[8:9] op_sel_hi:[1,0,0]
  v_pk_fma_f32 v[46:47], v[46:47], v[8:9], v[8:9] op_sel_hi:[1,0,0]
  v_rcp_f32 v40, v40
  v_rcp_f32 v41, v41
  v_rcp_f32 v42, v42
  v_rcp_f32 v43, v43
  v_rcp_f32 v44, v44
  v_rcp_f32 v45, v45
  v_rcp_f32 v46, v46
  v_rcp_f32 v47, v47
  v_pk_mul_f32 v[64:65], v[64:65], v[40:41]
  v_pk_mul_f32 v[66:67], v[66:67], v[42:43]
  v_pk_mul_f32 v[68:69], v[68:69], v[44:45]
  v_pk_mul_f32 v[70:71], v[70:71], v[46:47]
  v_cvt_pk_bf16_f32 v56, v64, v65
  v_cvt_pk_bf16_f32 v57, v66, v67
  v_cvt_pk_bf16_f32 v58, v68, v69
  v_cvt_pk_bf16_f32 v59, v70, v71
  s_add_u32 s81, s85, 0
  buffer_store_dwordx4 v[56:59], v1, s[16:19], s81 offen sc1
  v_pk_mul_f32 v[40:41], v[72:73], v[22:23] op_sel_hi:[1,0]
  v_pk_mul_f32 v[42:43], v[74:75], v[22:23] op_sel_hi:[1,0]
  v_pk_mul_f32 v[44:45], v[76:77], v[22:23] op_sel_hi:[1,0]
  v_pk_mul_f32 v[46:47], v[78:79], v[22:23] op_sel_hi:[1,0]
  v_exp_f32 v40, v40
  v_exp_f32 v41, v41
  v_exp_f32 v42, v42
  v_exp_f32 v43, v43
  v_exp_f32 v44, v44
  v_exp_f32 v45, v45
  v_exp_f32 v46, v46
  v_exp_f32 v47, v47
  v_pk_fma_f32 v[40:41], v[40:41], v[8:9], v[8:9] op_sel_hi:[1,0,0]
  v_pk_fma_f32 v[42:43], v[42:43], v[8:9], v[8:9] op_sel_hi:[1,0,0]
  v_pk_fma_f32 v[44:45], v[44:45], v[8:9], v[8:9] op_sel_hi:[1,0,0]
  v_pk_fma_f32 v[46:47], v[46:47], v[8:9], v[8:9] op_sel_hi:[1,0,0]
  v_rcp_f32 v40, v40
  v_rcp_f32 v41, v41
  v_rcp_f32 v42, v42
  v_rcp_f32 v43, v43
  v_rcp_f32 v44, v44
  v_rcp_f32 v45, v45
  v_rcp_f32 v46, v46
  v_rcp_f32 v47, v47
  v_pk_mul_f32 v[72:73], v[72:73], v[40:41]
  v_pk_mul_f32 v[74:75], v[74:75], v[42:43]
  v_pk_mul_f32 v[76:77], v[76:77], v[44:45]
  v_pk_mul_f32 v[78:79], v[78:79], v[46:47]
  v_cvt_pk_bf16_f32 v60, v72, v73
  v_cvt_pk_bf16_f32 v61, v74, v75
  v_cvt_pk_bf16_f32 v62, v76, v77
  v_cvt_pk_bf16_f32 v63, v78, v79
  s_add_u32 s81, s85, 2048
  buffer_store_dwordx4 v[60:63], v1, s[16:19], s81 offen sc1
  v_pk_mul_f32 v[40:41], v[80:81], v[22:23] op_sel:[0,1] op_sel_hi:[1,1]
  v_pk_mul_f32 v[42:43], v[82:83], v[22:23] op_sel:[0,1] op_sel_hi:[1,1]
  v_pk_mul_f32 v[44:45], v[84:85], v[22:23] op_sel:[0,1] op_sel_hi:[1,1]
  v_pk_mul_f32 v[46:47], v[86:87], v[22:23] op_sel:[0,1] op_sel_hi:[1,1]
  v_exp_f32 v40, v40
  v_exp_f32 v41, v41
  v_exp_f32 v42, v42
  v_exp_f32 v43, v43
  v_exp_f32 v44, v44
  v_exp_f32 v45, v45
  v_exp_f32 v46, v46
  v_exp_f32 v47, v47
  v_pk_fma_f32 v[40:41], v[40:41], v[8:9], v[8:9] op_sel:[0,1,1] op_sel_hi:[1,1,1]
  v_pk_fma_f32 v[42:43], v[42:43], v[8:9], v[8:9] op_sel:[0,1,1] op_sel_hi:[1,1,1]
  v_pk_fma_f32 v[44:45], v[44:45], v[8:9], v[8:9] op_sel:[0,1,1] op_sel_hi:[1,1,1]
  v_pk_fma_f32 v[46:47], v[46:47], v[8:9], v[8:9] op_sel:[0,1,1] op_sel_hi:[1,1,1]
  v_rcp_f32 v40, v40
  v_rcp_f32 v41, v41
  v_rcp_f32 v42, v42
  v_rcp_f32 v43, v43
  v_rcp_f32 v44, v44
  v_rcp_f32 v45, v45
  v_rcp_f32 v46, v46
  v_rcp_f32 v47, v47
  v_pk_mul_f32 v[80:81], v[80:81], v[40:41]
  v_pk_mul_f32 v[82:83], v[82:83], v[42:43]
  v_pk_mul_f32 v[84:85], v[84:85], v[44:45]
  v_pk_mul_f32 v[86:87], v[86:87], v[46:47]
  v_cvt_pk_bf16_f32 v56, v80, v81
  v_cvt_pk_bf16_f32 v57, v82, v83
  v_cvt_pk_bf16_f32 v58, v84, v85
  v_cvt_pk_bf16_f32 v59, v86, v87
  s_add_u32 s81, s87, 0
  buffer_store_dwordx4 v[56:59], v1, s[16:19], s81 offen sc1
  v_pk_mul_f32 v[40:41], v[88:89], v[22:23] op_sel:[0,1] op_sel_hi:[1,1]
  v_pk_mul_f32 v[42:43], v[90:91], v[22:23] op_sel:[0,1] op_sel_hi:[1,1]
  v_pk_mul_f32 v[44:45], v[92:93], v[22:23] op_sel:[0,1] op_sel_hi:[1,1]
  v_pk_mul_f32 v[46:47], v[94:95], v[22:23] op_sel:[0,1] op_sel_hi:[1,1]
  v_exp_f32 v40, v40
  v_exp_f32 v41, v41
  v_exp_f32 v42, v42
  v_exp_f32 v43, v43
  v_exp_f32 v44, v44
  v_exp_f32 v45, v45
  v_exp_f32 v46, v46
  v_exp_f32 v47, v47
  v_pk_fma_f32 v[40:41], v[40:41], v[8:9], v[8:9] op_sel:[0,1,1] op_sel_hi:[1,1,1]
  v_pk_fma_f32 v[42:43], v[42:43], v[8:9], v[8:9] op_sel:[0,1,1] op_sel_hi:[1,1,1]
  v_pk_fma_f32 v[44:45], v[44:45], v[8:9], v[8:9] op_sel:[0,1,1] op_sel_hi:[1,1,1]
  v_pk_fma_f32 v[46:47], v[46:47], v[8:9], v[8:9] op_sel:[0,1,1] op_sel_hi:[1,1,1]
  v_rcp_f32 v40, v40
  v_rcp_f32 v41, v41
  v_rcp_f32 v42, v42
  v_rcp_f32 v43, v43
  v_rcp_f32 v44, v44
  v_rcp_f32 v45, v45
  v_rcp_f32 v46, v46
  v_rcp_f32 v47, v47
  v_pk_mul_f32 v[88:89], v[88:89], v[40:41]
  v_pk_mul_f32 v[90:91], v[90:91], v[42:43]
  v_pk_mul_f32 v[92:93], v[92:93], v[44:45]
  v_pk_mul_f32 v[94:95], v[94:95], v[46:47]
  v_cvt_pk_bf16_f32 v60, v88, v89
  v_cvt_pk_bf16_f32 v61, v90, v91
  v_cvt_pk_bf16_f32 v62, v92, v93
  v_cvt_pk_bf16_f32 v63, v94, v95
  s_add_u32 s81, s87, 2048
  buffer_store_dwordx4 v[60:63], v1, s[16:19], s81 offen sc1
  v_pk_mul_f32 v[40:41], v[96:97], v[22:23] op_sel_hi:[1,0]
  v_pk_mul_f32 v[42:43], v[98:99], v[22:23] op_sel_hi:[1,0]
  v_pk_mul_f32 v[44:45], v[100:101], v[22:23] op_sel_hi:[1,0]
  v_pk_mul_f32 v[46:47], v[102:103], v[22:23] op_sel_hi:[1,0]
  v_exp_f32 v40, v40
  v_exp_f32 v41, v41
  v_exp_f32 v42, v42
  v_exp_f32 v43, v43
  v_exp_f32 v44, v44
  v_exp_f32 v45, v45
  v_exp_f32 v46, v46
  v_exp_f32 v47, v47
  v_pk_fma_f32 v[40:41], v[40:41], v[8:9], v[8:9] op_sel_hi:[1,0,0]
  v_pk_fma_f32 v[42:43], v[42:43], v[8:9], v[8:9] op_sel_hi:[1,0,0]
  v_pk_fma_f32 v[44:45], v[44:45], v[8:9], v[8:9] op_sel_hi:[1,0,0]
  v_pk_fma_f32 v[46:47], v[46:47], v[8:9], v[8:9] op_sel_hi:[1,0,0]
  v_rcp_f32 v40, v40
  v_rcp_f32 v41, v41
  v_rcp_f32 v42, v42
  v_rcp_f32 v43, v43
  v_rcp_f32 v44, v44
  v_rcp_f32 v45, v45
  v_rcp_f32 v46, v46
  v_rcp_f32 v47, v47
  v_pk_mul_f32 v[96:97], v[96:97], v[40:41]
  v_pk_mul_f32 v[98:99], v[98:99], v[42:43]
  v_pk_mul_f32 v[100:101], v[100:101], v[44:45]
  v_pk_mul_f32 v[102:103], v[102:103], v[46:47]
  v_cvt_pk_bf16_f32 v56, v96, v97
  v_cvt_pk_bf16_f32 v57, v98, v99
  v_cvt_pk_bf16_f32 v58, v100, v101
  v_cvt_pk_bf16_f32 v59, v102, v103
  s_add_u32 s81, s85, 4096
  buffer_store_dwordx4 v[56:59], v1, s[16:19], s81 offen sc1
  v_pk_mul_f32 v[40:41], v[104:105], v[22:23] op_sel_hi:[1,0]
  v_pk_mul_f32 v[42:43], v[106:107], v[22:23] op_sel_hi:[1,0]
  v_pk_mul_f32 v[44:45], v[108:109], v[22:23] op_sel_hi:[1,0]
  v_pk_mul_f32 v[46:47], v[110:111], v[22:23] op_sel_hi:[1,0]
  v_exp_f32 v40, v40
  v_exp_f32 v41, v41
  v_exp_f32 v42, v42
  v_exp_f32 v43, v43
  v_exp_f32 v44, v44
  v_exp_f32 v45, v45
  v_exp_f32 v46, v46
  v_exp_f32 v47, v47
  v_pk_fma_f32 v[40:41], v[40:41], v[8:9], v[8:9] op_sel_hi:[1,0,0]
  v_pk_fma_f32 v[42:43], v[42:43], v[8:9], v[8:9] op_sel_hi:[1,0,0]
  v_pk_fma_f32 v[44:45], v[44:45], v[8:9], v[8:9] op_sel_hi:[1,0,0]
  v_pk_fma_f32 v[46:47], v[46:47], v[8:9], v[8:9] op_sel_hi:[1,0,0]
  v_rcp_f32 v40, v40
  v_rcp_f32 v41, v41
  v_rcp_f32 v42, v42
  v_rcp_f32 v43, v43
  v_rcp_f32 v44, v44
  v_rcp_f32 v45, v45
  v_rcp_f32 v46, v46
  v_rcp_f32 v47, v47
  v_pk_mul_f32 v[104:105], v[104:105], v[40:41]
  v_pk_mul_f32 v[106:107], v[106:107], v[42:43]
  v_pk_mul_f32 v[108:109], v[108:109], v[44:45]
  v_pk_mul_f32 v[110:111], v[110:111], v[46:47]
  v_cvt_pk_bf16_f32 v60, v104, v105
  v_cvt_pk_bf16_f32 v61, v106, v107
  v_cvt_pk_bf16_f32 v62, v108, v109
  v_cvt_pk_bf16_f32 v63, v110, v111
  s_add_u32 s81, s85, 6144
  buffer_store_dwordx4 v[60:63], v1, s[16:19], s81 offen sc1
  v_pk_mul_f32 v[40:41], v[112:113], v[22:23] op_sel:[0,1] op_sel_hi:[1,1]
  v_pk_mul_f32 v[42:43], v[114:115], v[22:23] op_sel:[0,1] op_sel_hi:[1,1]
  v_pk_mul_f32 v[44:45], v[116:117], v[22:23] op_sel:[0,1] op_sel_hi:[1,1]
  v_pk_mul_f32 v[46:47], v[118:119], v[22:23] op_sel:[0,1] op_sel_hi:[1,1]
  v_exp_f32 v40, v40
  v_exp_f32 v41, v41
  v_exp_f32 v42, v42
  v_exp_f32 v43, v43
  v_exp_f32 v44, v44
  v_exp_f32 v45, v45
  v_exp_f32 v46, v46
  v_exp_f32 v47, v47
  v_pk_fma_f32 v[40:41], v[40:41], v[8:9], v[8:9] op_sel:[0,1,1] op_sel_hi:[1,1,1]
  v_pk_fma_f32 v[42:43], v[42:43], v[8:9], v[8:9] op_sel:[0,1,1] op_sel_hi:[1,1,1]
  v_pk_fma_f32 v[44:45], v[44:45], v[8:9], v[8:9] op_sel:[0,1,1] op_sel_hi:[1,1,1]
  v_pk_fma_f32 v[46:47], v[46:47], v[8:9], v[8:9] op_sel:[0,1,1] op_sel_hi:[1,1,1]
  v_rcp_f32 v40, v40
  v_rcp_f32 v41, v41
  v_rcp_f32 v42, v42
  v_rcp_f32 v43, v43
  v_rcp_f32 v44, v44
  v_rcp_f32 v45, v45
  v_rcp_f32 v46, v46
  v_rcp_f32 v47, v47
  v_pk_mul_f32 v[112:113], v[112:113], v[40:41]
  v_pk_mul_f32 v[114:115], v[114:115], v[42:43]
  v_pk_mul_f32 v[116:117], v[116:117], v[44:45]
  v_pk_mul_f32 v[118:119], v[118:119], v[46:47]
  v_cvt_pk_bf16_f32 v56, v112, v113
  v_cvt_pk_bf16_f32 v57, v114, v115
  v_cvt_pk_bf16_f32 v58, v116, v117
  v_cvt_pk_bf16_f32 v59, v118, v119
  s_add_u32 s81, s87, 4096
  buffer_store_dwordx4 v[56:59], v1, s[16:19], s81 offen sc1
  v_pk_mul_f32 v[40:41], v[120:121], v[22:23] op_sel:[0,1] op_sel_hi:[1,1]
  v_pk_mul_f32 v[42:43], v[122:123], v[22:23] op_sel:[0,1] op_sel_hi:[1,1]
  v_pk_mul_f32 v[44:45], v[124:125], v[22:23] op_sel:[0,1] op_sel_hi:[1,1]
  v_pk_mul_f32 v[46:47], v[126:127], v[22:23] op_sel:[0,1] op_sel_hi:[1,1]
  v_exp_f32 v40, v40
  v_exp_f32 v41, v41
  v_exp_f32 v42, v42
  v_exp_f32 v43, v43
  v_exp_f32 v44, v44
  v_exp_f32 v45, v45
  v_exp_f32 v46, v46
  v_exp_f32 v47, v47
  v_pk_fma_f32 v[40:41], v[40:41], v[8:9], v[8:9] op_sel:[0,1,1] op_sel_hi:[1,1,1]
  v_pk_fma_f32 v[42:43], v[42:43], v[8:9], v[8:9] op_sel:[0,1,1] op_sel_hi:[1,1,1]
  v_pk_fma_f32 v[44:45], v[44:45], v[8:9], v[8:9] op_sel:[0,1,1] op_sel_hi:[1,1,1]
  v_pk_fma_f32 v[46:47], v[46:47], v[8:9], v[8:9] op_sel:[0,1,1] op_sel_hi:[1,1,1]
  v_rcp_f32 v40, v40
  v_rcp_f32 v41, v41
  v_rcp_f32 v42, v42
  v_rcp_f32 v43, v43
  v_rcp_f32 v44, v44
  v_rcp_f32 v45, v45
  v_rcp_f32 v46, v46
  v_rcp_f32 v47, v47
  v_pk_mul_f32 v[120:121], v[120:121], v[40:41]
  v_pk_mul_f32 v[122:123], v[122:123], v[42:43]
  v_pk_mul_f32 v[124:125], v[124:125], v[44:45]
  v_pk_mul_f32 v[126:127], v[126:127], v[46:47]
  v_cvt_pk_bf16_f32 v60, v120, v121
  v_cvt_pk_bf16_f32 v61, v122, v123
  v_cvt_pk_bf16_f32 v62, v124, v125
  v_cvt_pk_bf16_f32 v63, v126, v127
  s_add_u32 s81, s87, 6144
  buffer_store_dwordx4 v[60:63], v1, s[16:19], s81 offen sc1
  s_mul_i32 s80, s31, 256
  s_add_u32 s80, s80, 15269888
  s_mul_i32 s81, s32, 16
  s_add_u32 s87, s80, s81
  v_and_b32 v1, 63, v0
  v_min_u32 v1, 13, v1
  v_mul_u32_u24 v1, 16, v1
  v_add_u32 v2, s80, v1
  s_waitcnt vmcnt(0)
  s_barrier
  s_cmp_lg_u32 s28, 0
  s_cbranch_scc1 S3_skip
  v_and_b32 v8, 63, v0
  v_mul_u32_u24 v8, 256, v8
  v_mov_b32 v10, s29
  v_mov_b32 v11, s29
  s_mov_b64 exec, 1
  buffer_store_dword v10, v8, s[8:11], s87 offen sc1
  s_mov_b64 exec, -1
S3_skip:
  s_lshr_b32 s80, s34, 1
  s_mul_i32 s80, s80, 114688
  s_and_b32 s81, s34, 1
  s_lshl_b32 s81, s81, 7
  s_add_u32 s80, s80, s81
  s_lshl_b32 s81, s35, 14
  s_add_u32 s80, s80, s81
  s_lshl_b32 s81, s28, 12
  s_add_u32 s80, s80, s81
  s_lshl_b32 s81, s28, 11
  s_add_u32 m0, s81, 147456
  s_nop 0
  buffer_load_dwordx4 v243, s[12:15], s80 offen sc1 lds
  s_add_u32 s80, s80, 2048
  s_add_u32 m0, s81, 148480
  s_nop 0
  buffer_load_dwordx4 v243, s[12:15], s80 offen sc1 lds
  s_add_u32 s80, s80, 2048
  v_and_b32 v10, 63, v0
  v_lshlrev_b32 v10, 4, v10
  s_add_u32 s80, s77, 20480
  v_add_u32 v9, s80, v10
  s_lshl_b32 s80, s28, 12
  s_add_u32 s80, s80, 20480
  v_add_u32 v8, s80, v10
  s_add_u32 s81, s28, 1
  s_and_b32 s81, s81, 3
  s_mul_i32 s81, s81, 36864
  v_add_u32 v4, s81, v8
  s_add_u32 s81, s28, 2
  s_and_b32 s81, s81, 3
  s_mul_i32 s81, s81, 36864
  v_add_u32 v5, s81, v8
  s_add_u32 s81, s28, 3
  s_and_b32 s81, s81, 3
  s_mul_i32 s81, s81, 36864
  v_add_u32 v6, s81, v8
  v_and_b32 v11, 31, v0
  v_bfe_u32 v12, v0, 5, 1
  v_mul_u32_u24 v11, 896, v11
  v_lshl_add_u32 v11, v12, 4, v11
  s_lshl_b32 s85, s34, 1
  s_add_u32 s85, s85, s73
  s_mul_i32 s85, s85, 28672
  s_lshl_b32 s81, s35, 7
  s_add_u32 s85, s85, s81
  s_lshl_b32 s81, s74, 6
  s_add_u32 s85, s85, s81
  s_mov_b32 s4, s100
  s_mov_b32 s5, s101
  s_mov_b32 s6, 1835008
  s_mov_b32 s7, 0x20000
  s_cmp_lg_u32 s28, 0
  s_cbranch_scc1 P3_skip
  buffer_load_dword v32, v2, s[8:11], 0 offen sc1
  s_mov_b32 s81, 0
P3_loop:
  s_waitcnt vmcnt(0)
  v_cmp_ne_u32 vcc, s29, v32
  s_cbranch_vccz P3_done
  buffer_load_dword v32, v2, s[8:11], 0 offen sc1
  s_sleep 1
  s_add_u32 s81, s81, 1
  s_cmp_lt_u32 s81, 100000
  s_cbranch_scc1 P3_loop
P3_done:
P3_skip:
  s_waitcnt vmcnt(0)
  s_barrier
  s_add_u32 s80, s76, 0
  buffer_load_dwordx4 v[128:131], v247, s[16:19], s80 offen sc1
  s_add_u32 s80, s76, 1024
  buffer_load_dwordx4 v[132:135], v247, s[16:19], s80 offen sc1
  s_add_u32 s80, s76, 2048
  buffer_load_dwordx4 v[136:139], v247, s[16:19], s80 offen sc1
  s_add_u32 s80, s76, 3072
  buffer_load_dwordx4 v[140:143], v247, s[16:19], s80 offen sc1
  s_add_u32 s80, s76, 4096
  buffer_load_dwordx4 v[144:147], v247, s[16:19], s80 offen sc1
  s_add_u32 s80, s76, 5120
  buffer_load_dwordx4 v[148:151], v247, s[16:19], s80 offen sc1
  s_add_u32 s80, s76, 6144
  buffer_load_dwordx4 v[152:155], v247, s[16:19], s80 offen sc1
  s_add_u32 s80, s76, 7168
  buffer_load_dwordx4 v[156:159], v247, s[16:19], s80 offen sc1
  s_add_u32 s80, s76, 8192
  buffer_load_dwordx4 v[160:163], v247, s[16:19], s80 offen sc1
  s_add_u32 s80, s76, 9216
  buffer_load_dwordx4 v[164:167], v247, s[16:19], s80 offen sc1
  s_add_u32 s80, s76, 10240
  buffer_load_dwordx4 v[168:171], v247, s[16:19], s80 offen sc1
  s_add_u32 s80, s76, 11264
  buffer_load_dwordx4 v[172:175], v247, s[16:19], s80 offen sc1
  s_add_u32 s80, s76, 12288
  buffer_load_dwordx4 v[176:179], v247, s[16:19], s80 offen sc1
  s_add_u32 s80, s76, 13312
  buffer_load_dwordx4 v[180:183], v247, s[16:19], s80 offen sc1
  s_add_u32 s80, s76, 14336
  buffer_load_dwordx4 v[184:187], v247, s[16:19], s80 offen sc1
  s_add_u32 s80, s76, 15360
  buffer_load_dwordx4 v[188:191], v247, s[16:19], s80 offen sc1
  s_add_u32 s80, s76, 16384
  buffer_load_dwordx4 v[192:195], v247, s[16:19], s80 offen sc1
  s_add_u32 s80, s76, 17408
  buffer_load_dwordx4 v[196:199], v247, s[16:19], s80 offen sc1
  s_add_u32 s80, s76, 18432
  buffer_load_dwordx4 v[200:203], v247, s[16:19], s80 offen sc1
  s_add_u32 s80, s76, 19456
  buffer_load_dwordx4 v[204:207], v247, s[16:19], s80 offen sc1
  s_add_u32 s80, s76, 20480
  buffer_load_dwordx4 v[208:211], v247, s[16:19], s80 offen sc1
  s_add_u32 s80, s76, 21504
  buffer_load_dwordx4 v[212:215], v247, s[16:19], s80 offen sc1
  s_add_u32 s80, s76, 22528
  buffer_load_dwordx4 v[216:219], v247, s[16:19], s80 offen sc1
  s_add_u32 s80, s76, 23552
  buffer_load_dwordx4 v[220:223], v247, s[16:19], s80 offen sc1
  s_add_u32 s80, s76, 24576
  buffer_load_dwordx4 v[224:227], v247, s[16:19], s80 offen sc1
  s_add_u32 s80, s76, 25600
  buffer_load_dwordx4 v[228:231], v247, s[16:19], s80 offen sc1
  s_waitcnt vmcnt(24)
  v_mfma_f32_32x32x16_bf16 v[64:79], a[0:3], v[128:131], 0
  v_mfma_f32_32x32x16_bf16 v[96:111], a[4:7], v[128:131], 0
  v_mfma_f32_32x32x16_bf16 v[80:95], a[0:3], v[132:135], 0
  s_add_u32 s80, s76, 26624
  buffer_load_dwordx4 v[232:235], v247, s[16:19], s80 offen sc1
  v_mfma_f32_32x32x16_bf16 v[112:127], a[4:7], v[132:135], 0
  s_add_u32 s80, s76, 27648
  buffer_load_dwordx4 v[236:239], v247, s[16:19], s80 offen sc1
  s_waitcnt vmcnt(24)
  v_mfma_f32_32x32x16_bf16 v[64:79], a[8:11], v[136:139], v[64:79]
  v_mfma_f32_32x32x16_bf16 v[96:111], a[12:15], v[136:139], v[96:111]
  v_mfma_f32_32x32x16_bf16 v[80:95], a[8:11], v[140:143], v[80:95]
  s_add_u32 s80, s76, 28672
  buffer_load_dwordx4 v[128:131], v247, s[16:19], s80 offen sc1
  v_mfma_f32_32x32x16_bf16 v[112:127], a[12:15], v[140:143], v[112:127]
  s_add_u32 s80, s76, 29696
  buffer_load_dwordx4 v[132:135], v247, s[16:19], s80 offen sc1
  s_waitcnt vmcnt(24)
  v_mfma_f32_32x32x16_bf16 v[64:79], a[16:19], v[144:147], v[64:79]
  v_mfma_f32_32x32x16_bf16 v[96:111], a[20:23], v[144:147], v[96:111]
  v_mfma_f32_32x32x16_bf16 v[80:95], a[16:19], v[148:151], v[80:95]
  s_add_u32 s80, s76, 30720
  buffer_load_dwordx4 v[136:139], v247, s[16:19], s80 offen sc1
  v_mfma_f32_32x32x16_bf16 v[112:127], a[20:23], v[148:151], v[112:127]
  s_add_u32 s80, s76, 31744
  buffer_load_dwordx4 v[140:143], v247, s[16:19], s80 offen sc1
  s_waitcnt vmcnt(24)
  v_mfma_f32_32x32x16_bf16 v[64:79], a[24:27], v[152:155], v[64:79]
  v_mfma_f32_32x32x16_bf16 v[96:111], a[28:31], v[152:155], v[96:111]
  v_mfma_f32_32x32x16_bf16 v[80:95], a[24:27], v[156:159], v[80:95]
  s_add_u32 s80, s76, 32768
  buffer_load_dwordx4 v[144:147], v247, s[16:19], s80 offen sc1
  v_mfma_f32_32x32x16_bf16 v[112:127], a[28:31], v[156:159], v[112:127]
  s_add_u32 s80, s76, 33792
  buffer_load_dwordx4 v[148:151], v247, s[16:19], s80 offen sc1
  s_waitcnt vmcnt(24)
  v_mfma_f32_32x32x16_bf16 v[64:79], a[32:35], v[160:163], v[64:79]
  v_mfma_f32_32x32x16_bf16 v[96:111], a[36:39], v[160:163], v[96:111]
  v_mfma_f32_32x32x16_bf16 v[80:95], a[32:35], v[164:167], v[80:95]
  s_add_u32 s80, s76, 34816
  buffer_load_dwordx4 v[152:155], v247, s[16:19], s80 offen sc1
  v_mfma_f32_32x32x16_bf16 v[112:127], a[36:39], v[164:167], v[112:127]
  s_add_u32 s80, s76, 35840
  buffer_load_dwordx4 v[156:159], v247, s[16:19], s80 offen sc1
  s_waitcnt vmcnt(24)
  v_mfma_f32_32x32x16_bf16 v[64:79], a[40:43], v[168:171], v[64:79]
  v_mfma_f32_32x32x16_bf16 v[96:111], a[44:47], v[168:171], v[96:111]
  v_mfma_f32_32x32x16_bf16 v[80:95], a[40:43], v[172:175], v[80:95]
  s_add_u32 s80, s76, 36864
  buffer_load_dwordx4 v[160:163], v247, s[16:19], s80 offen sc1
  v_mfma_f32_32x32x16_bf16 v[112:127], a[44:47], v[172:175], v[112:127]
  s_add_u32 s80, s76, 37888
  buffer_load_dwordx4 v[164:167], v247, s[16:19], s80 offen sc1
  s_waitcnt vmcnt(24)
  v_mfma_f32_32x32x16_bf16 v[64:79], a[48:51], v[176:179], v[64:79]
  v_mfma_f32_32x32x16_bf16 v[96:111], a[52:55], v[176:179], v[96:111]
  v_mfma_f32_32x32x16_bf16 v[80:95], a[48:51], v[180:183], v[80:95]
  s_add_u32 s80, s76, 38912
  buffer_load_dwordx4 v[168:171], v247, s[16:19], s80 offen sc1
  v_mfma_f32_32x32x16_bf16 v[112:127], a[52:55], v[180:183], v[112:127]
  s_add_u32 s80, s76, 39936
  buffer_load_dwordx4 v[172:175], v247, s[16:19], s80 offen sc1
  s_waitcnt vmcnt(24)
  v_mfma_f32_32x32x16_bf16 v[64:79], a[56:59], v[184:187], v[64:79]
  v_mfma_f32_32x32x16_bf16 v[96:111], a[60:63], v[184:187], v[96:111]
  v_mfma_f32_32x32x16_bf16 v[80:95], a[56:59], v[188:191], v[80:95]
  s_add_u32 s80, s76, 40960
  buffer_load_dwordx4 v[176:179], v247, s[16:19], s80 offen sc1
  v_mfma_f32_32x32x16_bf16 v[112:127], a[60:63], v[188:191], v[112:127]
  s_add_u32 s80, s76, 41984
  buffer_load_dwordx4 v[180:183], v247, s[16:19], s80 offen sc1
  s_waitcnt vmcnt(24)
  v_mfma_f32_32x32x16_bf16 v[64:79], a[64:67], v[192:195], v[64:79]
  v_mfma_f32_32x32x16_bf16 v[96:111], a[68:71], v[192:195], v[96:111]
  v_mfma_f32_32x32x16_bf16 v[80:95], a[64:67], v[196:199], v[80:95]
  s_add_u32 s80, s76, 43008
  buffer_load_dwordx4 v[184:187], v247, s[16:19], s80 offen sc1
  v_mfma_f32_32x32x16_bf16 v[112:127], a[68:71], v[196:199], v[112:127]
  s_add_u32 s80, s76, 44032
  buffer_load_dwordx4 v[188:191], v247, s[16:19], s80 offen sc1
  s_waitcnt vmcnt(24)
  v_mfma_f32_32x32x16_bf16 v[64:79], a[72:75], v[200:203], v[64:79]
  v_mfma_f32_32x32x16_bf16 v[96:111], a[76:79], v[200:203], v[96:111]
  v_mfma_f32_32x32x16_bf16 v[80:95], a[72:75], v[204:207], v[80:95]
  s_add_u32 s80, s76, 45056
  buffer_load_dwordx4 v[192:195], v247, s[16:19], s80 offen sc1
  v_mfma_f32_32x32x16_bf16 v[112:127], a[76:79], v[204:207], v[112:127]
  s_add_u32 s80, s76, 46080
  buffer_load_dwordx4 v[196:199], v247, s[16:19], s80 offen sc1
  s_waitcnt vmcnt(24)
  v_mfma_f32_32x32x16_bf16 v[64:79], a[80:83], v[208:211], v[64:79]
  v_mfma_f32_32x32x16_bf16 v[96:111], a[84:87], v[208:211], v[96:111]
  v_mfma_f32_32x32x16_bf16 v[80:95], a[80:83], v[212:215], v[80:95]
  s_add_u32 s80, s76, 47104
  buffer_load_dwordx4 v[200:203], v247, s[16:19], s80 offen sc1
  v_mfma_f32_32x32x16_bf16 v[112:127], a[84:87], v[212:215], v[112:127]
  s_add_u32 s80, s76, 48128
  buffer_load_dwordx4 v[204:207], v247, s[16:19], s80 offen sc1
  s_waitcnt vmcnt(24)
  v_mfma_f32_32x32x16_bf16 v[64:79], a[88:91], v[216:219], v[64:79]
  v_mfma_f32_32x32x16_bf16 v[96:111], a[92:95], v[216:219], v[96:111]
  v_mfma_f32_32x32x16_bf16 v[80:95], a[88:91], v[220:223], v[80:95]
  s_add_u32 s80, s76, 49152
  buffer_load_dwordx4 v[208:211], v247, s[16:19], s80 offen sc1
  v_mfma_f32_32x32x16_bf16 v[112:127], a[92:95], v[220:223], v[112:127]
  s_add_u32 s80, s76, 50176
  buffer_load_dwordx4 v[212:215], v247, s[16:19], s80 offen sc1
  s_waitcnt vmcnt(24)
  v_mfma_f32_32x32x16_bf16 v[64:79], a[96:99], v[224:227], v[64:79]
  v_mfma_f32_32x32x16_bf16 v[96:111], a[100:103], v[224:227], v[96:111]
  v_mfma_f32_32x32x16_bf16 v[80:95], a[96:99], v[228:231], v[80:95]
  s_add_u32 s80, s76, 51200
  buffer_load_dwordx4 v[216:219], v247, s[16:19], s80 offen sc1
  v_mfma_f32_32x32x16_bf16 v[112:127], a[100:103], v[228:231], v[112:127]
  s_add_u32 s80, s76, 52224
  buffer_load_dwordx4 v[220:223], v247, s[16:19], s80 offen sc1
  s_waitcnt vmcnt(24)
  v_mfma_f32_32x32x16_bf16 v[64:79], a[104:107], v[232:235], v[64:79]
  v_mfma_f32_32x32x16_bf16 v[96:111], a[108:111], v[232:235], v[96:111]
  v_mfma_f32_32x32x16_bf16 v[80:95], a[104:107], v[236:239], v[80:95]
  s_add_u32 s80, s76, 53248
  buffer_load_dwordx4 v[224:227], v247, s[16:19], s80 offen sc1
  v_mfma_f32_32x32x16_bf16 v[112:127], a[108:111], v[236:239], v[112:127]
  s_add_u32 s80, s76, 54272
  buffer_load_dwordx4 v[228:231], v247, s[16:19], s80 offen sc1
  s_waitcnt vmcnt(24)
  v_mfma_f32_32x32x16_bf16 v[64:79], a[112:115], v[128:131], v[64:79]
  v_mfma_f32_32x32x16_bf16 v[96:111], a[116:119], v[128:131], v[96:111]
  v_mfma_f32_32x32x16_bf16 v[80:95], a[112:115], v[132:135], v[80:95]
  s_add_u32 s80, s76, 55296
  buffer_load_dwordx4 v[232:235], v247, s[16:19], s80 offen sc1
  v_mfma_f32_32x32x16_bf16 v[112:127], a[116:119], v[132:135], v[112:127]
  s_add_u32 s80, s76, 56320
  buffer_load_dwordx4 v[236:239], v247, s[16:19], s80 offen sc1
  s_waitcnt vmcnt(24)
  v_mfma_f32_32x32x16_bf16 v[64:79], a[120:123], v[136:139], v[64:79]
  v_mfma_f32_32x32x16_bf16 v[96:111], a[124:127], v[136:139], v[96:111]
  v_mfma_f32_32x32x16_bf16 v[80:95], a[120:123], v[140:143], v[80:95]
  v_mfma_f32_32x32x16_bf16 v[112:127], a[124:127], v[140:143], v[112:127]
  s_waitcnt vmcnt(22)
  v_mfma_f32_32x32x16_bf16 v[64:79], a[128:131], v[144:147], v[64:79]
  v_mfma_f32_32x32x16_bf16 v[96:111], a[132:135], v[144:147], v[96:111]
  v_mfma_f32_32x32x16_bf16 v[80:95], a[128:131], v[148:151], v[80:95]
  v_mfma_f32_32x32x16_bf16 v[112:127], a[132:135], v[148:151], v[112:127]
  s_waitcnt vmcnt(20)
  v_mfma_f32_32x32x16_bf16 v[64:79], a[136:139], v[152:155], v[64:79]
  v_mfma_f32_32x32x16_bf16 v[96:111], a[140:143], v[152:155], v[96:111]
  v_mfma_f32_32x32x16_bf16 v[80:95], a[136:139], v[156:159], v[80:95]
  v_mfma_f32_32x32x16_bf16 v[112:127], a[140:143], v[156:159], v[112:127]
  s_waitcnt vmcnt(18)
  v_mfma_f32_32x32x16_bf16 v[64:79], a[144:147], v[160:163], v[64:79]
  v_mfma_f32_32x32x16_bf16 v[96:111], a[148:151], v[160:163], v[96:111]
  v_mfma_f32_32x32x16_bf16 v[80:95], a[144:147], v[164:167], v[80:95]
  v_mfma_f32_32x32x16_bf16 v[112:127], a[148:151], v[164:167], v[112:127]
  s_waitcnt vmcnt(16)
  v_mfma_f32_32x32x16_bf16 v[64:79], a[152:155], v[168:171], v[64:79]
  v_mfma_f32_32x32x16_bf16 v[96:111], a[156:159], v[168:171], v[96:111]
  v_mfma_f32_32x32x16_bf16 v[80:95], a[152:155], v[172:175], v[80:95]
  v_mfma_f32_32x32x16_bf16 v[112:127], a[156:159], v[172:175], v[112:127]
  s_waitcnt vmcnt(14)
  v_mfma_f32_32x32x16_bf16 v[64:79], a[160:163], v[176:179], v[64:79]
  v_mfma_f32_32x32x16_bf16 v[96:111], a[164:167], v[176:179], v[96:111]
  v_mfma_f32_32x32x16_bf16 v[80:95], a[160:163], v[180:183], v[80:95]
  v_mfma_f32_32x32x16_bf16 v[112:127], a[164:167], v[180:183], v[112:127]
  s_waitcnt vmcnt(12)
  v_mfma_f32_32x32x16_bf16 v[64:79], a[168:171], v[184:187], v[64:79]
  v_mfma_f32_32x32x16_bf16 v[96:111], a[172:175], v[184:187], v[96:111]
  v_mfma_f32_32x32x16_bf16 v[80:95], a[168:171], v[188:191], v[80:95]
  v_mfma_f32_32x32x16_bf16 v[112:127], a[172:175], v[188:191], v[112:127]
  s_waitcnt vmcnt(10)
  v_mfma_f32_32x32x16_bf16 v[64:79], a[176:179], v[192:195], v[64:79]
  v_mfma_f32_32x32x16_bf16 v[96:111], a[180:183], v[192:195], v[96:111]
  v_mfma_f32_32x32x16_bf16 v[80:95], a[176:179], v[196:199], v[80:95]
  v_mfma_f32_32x32x16_bf16 v[112:127], a[180:183], v[196:199], v[112:127]
  s_waitcnt vmcnt(8)
  v_mfma_f32_32x32x16_bf16 v[64:79], a[184:187], v[200:203], v[64:79]
  v_mfma_f32_32x32x16_bf16 v[96:111], a[188:191], v[200:203], v[96:111]
  v_mfma_f32_32x32x16_bf16 v[80:95], a[184:187], v[204:207], v[80:95]
  v_mfma_f32_32x32x16_bf16 v[112:127], a[188:191], v[204:207], v[112:127]
  s_waitcnt vmcnt(0)
  s_cmp_lg_u32 s28, 0
  s_cbranch_scc1 G2_v1
  v_mfma_f32_32x32x16_bf16 v[96:111], a[196:199], v[208:211], v[96:111]
  v_mfma_f32_32x32x16_bf16 v[80:95], a[192:195], v[212:215], v[80:95]
  ds_read_b64_tr_b16 v[16:17], v246 offset:0
  ds_read_b64_tr_b16 v[18:19], v246 offset:1024
  ds_read_b64_tr_b16 v[20:21], v246 offset:2048
  ds_read_b64_tr_b16 v[22:23], v246 offset:3072
  v_mfma_f32_32x32x16_bf16 v[96:111], a[204:207], v[216:219], v[96:111]
  v_mfma_f32_32x32x16_bf16 v[80:95], a[200:203], v[220:223], v[80:95]
  v_mfma_f32_32x32x16_bf16 v[96:111], a[212:215], v[224:227], v[96:111]
  v_mfma_f32_32x32x16_bf16 v[80:95], a[208:211], v[228:231], v[80:95]
  v_mfma_f32_32x32x16_bf16 v[96:111], a[220:223], v[232:235], v[96:111]
  v_mfma_f32_32x32x16_bf16 v[80:95], a[216:219], v[236:239], v[80:95]
  v_mfma_f32_32x32x16_bf16 v[112:127], a[196:199], v[212:215], v[112:127]
  s_waitcnt lgkmcnt(0)
  v_lshlrev_b32 v32, 16, v16
  v_and_b32 v33, s91, v16
  v_lshlrev_b32 v34, 16, v17
  v_and_b32 v35, s91, v17
  v_mfma_f32_32x32x16_bf16 v[64:79], a[192:195], v[208:211], v[64:79]
  v_lshlrev_b32 v36, 16, v18
  v_and_b32 v37, s91, v18
  v_lshlrev_b32 v38, 16, v19
  v_and_b32 v39, s91, v19
  v_mfma_f32_32x32x16_bf16 v[112:127], a[204:207], v[220:223], v[112:127]
  ds_write_b128 v9, v[96:99] offset:4096
  ds_write_b128 v9, v[100:103] offset:5120
  v_mfma_f32_32x32x16_bf16 v[64:79], a[200:203], v[216:219], v[64:79]
  ds_write_b128 v9, v[104:107] offset:6144
  ds_write_b128 v9, v[108:111] offset:7168
  v_mfma_f32_32x32x16_bf16 v[112:127], a[212:215], v[228:231], v[112:127]
  ds_write_b128 v9, v[80:83] offset:8192
  ds_write_b128 v9, v[84:87] offset:9216
  v_mfma_f32_32x32x16_bf16 v[64:79], a[208:211], v[224:227], v[64:79]
  ds_write_b128 v9, v[88:91] offset:10240
  ds_write_b128 v9, v[92:95] offset:11264
  v_mfma_f32_32x32x16_bf16 v[112:127], a[220:223], v[236:239], v[112:127]
  v_mfma_f32_32x32x16_bf16 v[64:79], a[216:219], v[232:235], v[64:79]
  v_lshlrev_b32 v40, 16, v20
  v_and_b32 v41, s91, v20
  v_lshlrev_b32 v42, 16, v21
  v_and_b32 v43, s91, v21
  v_lshlrev_b32 v44, 16, v22
  v_and_b32 v45, s91, v22
  v_lshlrev_b32 v46, 16, v23
  v_and_b32 v47, s91, v23
  s_nop 2
  ds_write_b128 v9, v[112:115] offset:12288
  ds_write_b128 v9, v[116:119] offset:13312
  ds_write_b128 v9, v[120:123] offset:14336
  ds_write_b128 v9, v[124:127] offset:15360
  s_waitcnt lgkmcnt(0)
  s_barrier
  ds_read_b128 v[96:99], v4 offset:0
  ds_read_b128 v[100:103], v4 offset:1024
  ds_read_b128 v[104:107], v4 offset:2048
  ds_read_b128 v[108:111], v4 offset:3072
  ds_read_b128 v[80:83], v5 offset:0
  ds_read_b128 v[84:87], v5 offset:1024
  ds_read_b128 v[88:91], v5 offset:2048
  ds_read_b128 v[92:95], v5 offset:3072
  ds_read_b128 v[112:115], v6 offset:0
  ds_read_b128 v[116:119], v6 offset:1024
  ds_read_b128 v[120:123], v6 offset:2048
  ds_read_b128 v[124:127], v6 offset:3072
  s_waitcnt lgkmcnt(8)
  v_pk_add_f32 v[64:65], v[64:65], v[96:97]
  v_pk_add_f32 v[66:67], v[66:67], v[98:99]
  v_pk_add_f32 v[68:69], v[68:69], v[100:101]
  v_pk_add_f32 v[70:71], v[70:71], v[102:103]
  v_pk_add_f32 v[72:73], v[72:73], v[104:105]
  v_pk_add_f32 v[74:75], v[74:75], v[106:107]
  v_pk_add_f32 v[76:77], v[76:77], v[108:109]
  v_pk_add_f32 v[78:79], v[78:79], v[110:111]
  s_waitcnt lgkmcnt(4)
  v_pk_add_f32 v[64:65], v[64:65], v[80:81]
  v_pk_add_f32 v[66:67], v[66:67], v[82:83]
  v_pk_add_f32 v[68:69], v[68:69], v[84:85]
  v_pk_add_f32 v[70:71], v[70:71], v[86:87]
  v_pk_add_f32 v[72:73], v[72:73], v[88:89]
  v_pk_add_f32 v[74:75], v[74:75], v[90:91]
  v_pk_add_f32 v[76:77], v[76:77], v[92:93]
  v_pk_add_f32 v[78:79], v[78:79], v[94:95]
  s_waitcnt lgkmcnt(0)
  v_pk_add_f32 v[64:65], v[64:65], v[112:113]
  v_pk_add_f32 v[66:67], v[66:67], v[114:115]
  v_pk_add_f32 v[68:69], v[68:69], v[116:117]
  v_pk_add_f32 v[70:71], v[70:71], v[118:119]
  v_pk_add_f32 v[72:73], v[72:73], v[120:121]
  v_pk_add_f32 v[74:75], v[74:75], v[122:123]
  v_pk_add_f32 v[76:77], v[76:77], v[124:125]
  v_pk_add_f32 v[78:79], v[78:79], v[126:127]
  v_cvt_pk_bf16_f32 v16, v64, v65
  v_lshlrev_b32 v64, 16, v16
  v_and_b32 v65, s91, v16
  v_cvt_pk_bf16_f32 v17, v66, v67
  v_lshlrev_b32 v66, 16, v17
  v_and_b32 v67, s91, v17
  v_cvt_pk_bf16_f32 v18, v68, v69
  v_lshlrev_b32 v68, 16, v18
  v_and_b32 v69, s91, v18
  v_cvt_pk_bf16_f32 v19, v70, v71
  v_lshlrev_b32 v70, 16, v19
  v_and_b32 v71, s91, v19
  v_pk_add_f32 v[64:65], v[64:65], v[32:33]
  v_pk_add_f32 v[66:67], v[66:67], v[34:35]
  v_pk_add_f32 v[68:69], v[68:69], v[36:37]
  v_pk_add_f32 v[70:71], v[70:71], v[38:39]
  v_cvt_pk_bf16_f32 v16, v64, v65
  v_cvt_pk_bf16_f32 v17, v66, v67
  v_cvt_pk_bf16_f32 v18, v68, v69
  v_cvt_pk_bf16_f32 v19, v70, v71
  s_nop 0
  v_permlane32_swap_b32 v16, v18
  v_permlane32_swap_b32 v17, v19
  buffer_store_dwordx4 v[16:19], v11, s[4:7], s85 offen offset:0
  v_cvt_pk_bf16_f32 v20, v72, v73
  v_lshlrev_b32 v72, 16, v20
  v_and_b32 v73, s91, v20
  v_cvt_pk_bf16_f32 v21, v74, v75
  v_lshlrev_b32 v74, 16, v21
  v_and_b32 v75, s91, v21
  v_cvt_pk_bf16_f32 v22, v76, v77
  v_lshlrev_b32 v76, 16, v22
  v_and_b32 v77, s91, v22
  v_cvt_pk_bf16_f32 v23, v78, v79
  v_lshlrev_b32 v78, 16, v23
  v_and_b32 v79, s91, v23
  v_pk_add_f32 v[72:73], v[72:73], v[40:41]
  v_pk_add_f32 v[74:75], v[74:75], v[42:43]
  v_pk_add_f32 v[76:77], v[76:77], v[44:45]
  v_pk_add_f32 v[78:79], v[78:79], v[46:47]
  v_cvt_pk_bf16_f32 v20, v72, v73
  v_cvt_pk_bf16_f32 v21, v74, v75
  v_cvt_pk_bf16_f32 v22, v76, v77
  v_cvt_pk_bf16_f32 v23, v78, v79
  s_nop 0
  v_permlane32_swap_b32 v20, v22
  v_permlane32_swap_b32 v21, v23
  buffer_store_dwordx4 v[20:23], v11, s[4:7], s85 offen offset:32
  s_branch G2_end
G2_v1:
  s_cmp_lg_u32 s28, 1
  s_cbranch_scc1 G2_v2
  v_mfma_f32_32x32x16_bf16 v[80:95], a[192:195], v[212:215], v[80:95]
  v_mfma_f32_32x32x16_bf16 v[112:127], a[196:199], v[212:215], v[112:127]
  ds_read_b64_tr_b16 v[16:17], v246 offset:0
  ds_read_b64_tr_b16 v[18:19], v246 offset:1024
  ds_read_b64_tr_b16 v[20:21], v246 offset:2048
  ds_read_b64_tr_b16 v[22:23], v246 offset:3072
  v_mfma_f32_32x32x16_bf16 v[80:95], a[200:203], v[220:223], v[80:95]
  v_mfma_f32_32x32x16_bf16 v[112:127], a[204:207], v[220:223], v[112:127]
  v_mfma_f32_32x32x16_bf16 v[80:95], a[208:211], v[228:231], v[80:95]
  v_mfma_f32_32x32x16_bf16 v[112:127], a[212:215], v[228:231], v[112:127]
  v_mfma_f32_32x32x16_bf16 v[80:95], a[216:219], v[236:239], v[80:95]
  v_mfma_f32_32x32x16_bf16 v[112:127], a[220:223], v[236:239], v[112:127]
  v_mfma_f32_32x32x16_bf16 v[64:79], a[192:195], v[208:211], v[64:79]
  s_waitcnt lgkmcnt(0)
  v_lshlrev_b32 v32, 16, v16
  v_and_b32 v33, s91, v16
  v_lshlrev_b32 v34, 16, v17
  v_and_b32 v35, s91, v17
  v_mfma_f32_32x32x16_bf16 v[96:111], a[196:199], v[208:211], v[96:111]
  v_lshlrev_b32 v36, 16, v18
  v_and_b32 v37, s91, v18
  v_lshlrev_b32 v38, 16, v19
  v_and_b32 v39, s91, v19
  v_mfma_f32_32x32x16_bf16 v[64:79], a[200:203], v[216:219], v[64:79]
  ds_write_b128 v9, v[80:83] offset:8192
  ds_write_b128 v9, v[84:87] offset:9216
  v_mfma_f32_32x32x16_bf16 v[96:111], a[204:207], v[216:219], v[96:111]
  ds_write_b128 v9, v[88:91] offset:10240
  ds_write_b128 v9, v[92:95] offset:11264
  v_mfma_f32_32x32x16_bf16 v[64:79], a[208:211], v[224:227], v[64:79]
  ds_write_b128 v9, v[112:115] offset:12288
  ds_write_b128 v9, v[116:119] offset:13312
  v_mfma_f32_32x32x16_bf16 v[96:111], a[212:215], v[224:227], v[96:111]
  ds_write_b128 v9, v[120:123] offset:14336
  ds_write_b128 v9, v[124:127] offset:15360
  v_mfma_f32_32x32x16_bf16 v[64:79], a[216:219], v[232:235], v[64:79]
  v_mfma_f32_32x32x16_bf16 v[96:111], a[220:223], v[232:235], v[96:111]
  v_lshlrev_b32 v40, 16, v20
  v_and_b32 v41, s91, v20
  v_lshlrev_b32 v42, 16, v21
  v_and_b32 v43, s91, v21
  v_lshlrev_b32 v44, 16, v22
  v_and_b32 v45, s91, v22
  v_lshlrev_b32 v46, 16, v23
  v_and_b32 v47, s91, v23
  s_nop 2
  ds_write_b128 v9, v[64:67] offset:0
  ds_write_b128 v9, v[68:71] offset:1024
  ds_write_b128 v9, v[72:75] offset:2048
  ds_write_b128 v9, v[76:79] offset:3072
  s_waitcnt lgkmcnt(0)
  s_barrier
  ds_read_b128 v[80:83], v4 offset:0
  ds_read_b128 v[84:87], v4 offset:1024
  ds_read_b128 v[88:91], v4 offset:2048
  ds_read_b128 v[92:95], v4 offset:3072
  ds_read_b128 v[112:115], v5 offset:0
  ds_read_b128 v[116:119], v5 offset:1024
  ds_read_b128 v[120:123], v5 offset:2048
  ds_read_b128 v[124:127], v5 offset:3072
  ds_read_b128 v[64:67], v6 offset:0
  ds_read_b128 v[68:71], v6 offset:1024
  ds_read_b128 v[72:75], v6 offset:2048
  ds_read_b128 v[76:79], v6 offset:3072
  s_waitcnt lgkmcnt(8)
  v_pk_add_f32 v[96:97], v[96:97], v[80:81]
  v_pk_add_f32 v[98:99], v[98:99], v[82:83]
  v_pk_add_f32 v[100:101], v[100:101], v[84:85]
  v_pk_add_f32 v[102:103], v[102:103], v[86:87]
  v_pk_add_f32 v[104:105], v[104:105], v[88:89]
  v_pk_add_f32 v[106:107], v[106:107], v[90:91]
  v_pk_add_f32 v[108:109], v[108:109], v[92:93]
  v_pk_add_f32 v[110:111], v[110:111], v[94:95]
  s_waitcnt lgkmcnt(4)
  v_pk_add_f32 v[96:97], v[96:97], v[112:113]
  v_pk_add_f32 v[98:99], v[98:99], v[114:115]
  v_pk_add_f32 v[100:101], v[100:101], v[116:117]
  v_pk_add_f32 v[102:103], v[102:103], v[118:119]
  v_pk_add_f32 v[104:105], v[104:105], v[120:121]
  v_pk_add_f32 v[106:107], v[106:107], v[122:123]
  v_pk_add_f32 v[108:109], v[108:109], v[124:125]
  v_pk_add_f32 v[110:111], v[110:111], v[126:127]
  s_waitcnt lgkmcnt(0)
  v_pk_add_f32 v[96:97], v[96:97], v[64:65]
  v_pk_add_f32 v[98:99], v[98:99], v[66:67]
  v_pk_add_f32 v[100:101], v[100:101], v[68:69]
  v_pk_add_f32 v[102:103], v[102:103], v[70:71]
  v_pk_add_f32 v[104:105], v[104:105], v[72:73]
  v_pk_add_f32 v[106:107], v[106:107], v[74:75]
  v_pk_add_f32 v[108:109], v[108:109], v[76:77]
  v_pk_add_f32 v[110:111], v[110:111], v[78:79]
  v_cvt_pk_bf16_f32 v16, v96, v97
  v_lshlrev_b32 v96, 16, v16
  v_and_b32 v97, s91, v16
  v_cvt_pk_bf16_f32 v17, v98, v99
  v_lshlrev_b32 v98, 16, v17
  v_and_b32 v99, s91, v17
  v_cvt_pk_bf16_f32 v18, v100, v101
  v_lshlrev_b32 v100, 16, v18
  v_and_b32 v101, s91, v18
  v_cvt_pk_bf16_f32 v19, v102, v103
  v_lshlrev_b32 v102, 16, v19
  v_and_b32 v103, s91, v19
  v_pk_add_f32 v[96:97], v[96:97], v[32:33]
  v_pk_add_f32 v[98:99], v[98:99], v[34:35]
  v_pk_add_f32 v[100:101], v[100:101], v[36:37]
  v_pk_add_f32 v[102:103], v[102:103], v[38:39]
  v_cvt_pk_bf16_f32 v16, v96, v97
  v_cvt_pk_bf16_f32 v17, v98, v99
  v_cvt_pk_bf16_f32 v18, v100, v101
  v_cvt_pk_bf16_f32 v19, v102, v103
  s_nop 0
  v_permlane32_swap_b32 v16, v18
  v_permlane32_swap_b32 v17, v19
  buffer_store_dwordx4 v[16:19], v11, s[4:7], s85 offen offset:0
  v_cvt_pk_bf16_f32 v20, v104, v105
  v_lshlrev_b32 v104, 16, v20
  v_and_b32 v105, s91, v20
  v_cvt_pk_bf16_f32 v21, v106, v107
  v_lshlrev_b32 v106, 16, v21
  v_and_b32 v107, s91, v21
  v_cvt_pk_bf16_f32 v22, v108, v109
  v_lshlrev_b32 v108, 16, v22
  v_and_b32 v109, s91, v22
  v_cvt_pk_bf16_f32 v23, v110, v111
  v_lshlrev_b32 v110, 16, v23
  v_and_b32 v111, s91, v23
  v_pk_add_f32 v[104:105], v[104:105], v[40:41]
  v_pk_add_f32 v[106:107], v[106:107], v[42:43]
  v_pk_add_f32 v[108:109], v[108:109], v[44:45]
  v_pk_add_f32 v[110:111], v[110:111], v[46:47]
  v_cvt_pk_bf16_f32 v20, v104, v105
  v_cvt_pk_bf16_f32 v21, v106, v107
  v_cvt_pk_bf16_f32 v22, v108, v109
  v_cvt_pk_bf16_f32 v23, v110, v111
  s_nop 0
  v_permlane32_swap_b32 v20, v22
  v_permlane32_swap_b32 v21, v23
  buffer_store_dwordx4 v[20:23], v11, s[4:7], s85 offen offset:32
  s_branch G2_end
G2_v2:
  s_cmp_lg_u32 s28, 2
  s_cbranch_scc1 G2_v3
  v_mfma_f32_32x32x16_bf16 v[112:127], a[196:199], v[212:215], v[112:127]
  v_mfma_f32_32x32x16_bf16 v[64:79], a[192:195], v[208:211], v[64:79]
  ds_read_b64_tr_b16 v[16:17], v246 offset:0
  ds_read_b64_tr_b16 v[18:19], v246 offset:1024
  ds_read_b64_tr_b16 v[20:21], v246 offset:2048
  ds_read_b64_tr_b16 v[22:23], v246 offset:3072
  v_mfma_f32_32x32x16_bf16 v[112:127], a[204:207], v[220:223], v[112:127]
  v_mfma_f32_32x32x16_bf16 v[64:79], a[200:203], v[216:219], v[64:79]
  v_mfma_f32_32x32x16_bf16 v[112:127], a[212:215], v[228:231], v[112:127]
  v_mfma_f32_32x32x16_bf16 v[64:79], a[208:211], v[224:227], v[64:79]
  v_mfma_f32_32x32x16_bf16 v[112:127], a[220:223], v[236:239], v[112:127]
  v_mfma_f32_32x32x16_bf16 v[64:79], a[216:219], v[232:235], v[64:79]
  v_mfma_f32_32x32x16_bf16 v[96:111], a[196:199], v[208:211], v[96:111]
  s_waitcnt lgkmcnt(0)
  v_lshlrev_b32 v32, 16, v16
  v_and_b32 v33, s91, v16
  v_lshlrev_b32 v34, 16, v17
  v_and_b32 v35, s91, v17
  v_mfma_f32_32x32x16_bf16 v[80:95], a[192:195], v[212:215], v[80:95]
  v_lshlrev_b32 v36, 16, v18
  v_and_b32 v37, s91, v18
  v_lshlrev_b32 v38, 16, v19
  v_and_b32 v39, s91, v19
  v_mfma_f32_32x32x16_bf16 v[96:111], a[204:207], v[216:219], v[96:111]
  ds_write_b128 v9, v[112:115] offset:12288
  ds_write_b128 v9, v[116:119] offset:13312
  v_mfma_f32_32x32x16_bf16 v[80:95], a[200:203], v[220:223], v[80:95]
  ds_write_b128 v9, v[120:123] offset:14336
  ds_write_b128 v9, v[124:127] offset:15360
  v_mfma_f32_32x32x16_bf16 v[96:111], a[212:215], v[224:227], v[96:111]
  ds_write_b128 v9, v[64:67] offset:0
  ds_write_b128 v9, v[68:71] offset:1024
  v_mfma_f32_32x32x16_bf16 v[80:95], a[208:211], v[228:231], v[80:95]
  ds_write_b128 v9, v[72:75] offset:2048
  ds_write_b128 v9, v[76:79] offset:3072
  v_mfma_f32_32x32x16_bf16 v[96:111], a[220:223], v[232:235], v[96:111]
  v_mfma_f32_32x32x16_bf16 v[80:95], a[216:219], v[236:239], v[80:95]
  v_lshlrev_b32 v40, 16, v20
  v_and_b32 v41, s91, v20
  v_lshlrev_b32 v42, 16, v21
  v_and_b32 v43, s91, v21
  v_lshlrev_b32 v44, 16, v22
  v_and_b32 v45, s91, v22
  v_lshlrev_b32 v46, 16, v23
  v_and_b32 v47, s91, v23
  s_nop 2
  ds_write_b128 v9, v[96:99] offset:4096
  ds_write_b128 v9, v[100:103] offset:5120
  ds_write_b128 v9, v[104:107] offset:6144
  ds_write_b128 v9, v[108:111] offset:7168
  s_waitcnt lgkmcnt(0)
  s_barrier
  ds_read_b128 v[112:115], v4 offset:0
  ds_read_b128 v[116:119], v4 offset:1024
  ds_read_b128 v[120:123], v4 offset:2048
  ds_read_b128 v[124:127], v4 offset:3072
  ds_read_b128 v[64:67], v5 offset:0
  ds_read_b128 v[68:71], v5 offset:1024
  ds_read_b128 v[72:75], v5 offset:2048
  ds_read_b128 v[76:79], v5 offset:3072
  ds_read_b128 v[96:99], v6 offset:0
  ds_read_b128 v[100:103], v6 offset:1024
  ds_read_b128 v[104:107], v6 offset:2048
  ds_read_b128 v[108:111], v6 offset:3072
  s_waitcnt lgkmcnt(8)
  v_pk_add_f32 v[80:81], v[80:81], v[112:113]
  v_pk_add_f32 v[82:83], v[82:83], v[114:115]
  v_pk_add_f32 v[84:85], v[84:85], v[116:117]
  v_pk_add_f32 v[86:87], v[86:87], v[118:119]
  v_pk_add_f32 v[88:89], v[88:89], v[120:121]
  v_pk_add_f32 v[90:91], v[90:91], v[122:123]
  v_pk_add_f32 v[92:93], v[92:93], v[124:125]
  v_pk_add_f32 v[94:95], v[94:95], v[126:127]
  s_waitcnt lgkmcnt(4)
  v_pk_add_f32 v[80:81], v[80:81], v[64:65]
  v_pk_add_f32 v[82:83], v[82:83], v[66:67]
  v_pk_add_f32 v[84:85], v[84:85], v[68:69]
  v_pk_add_f32 v[86:87], v[86:87], v[70:71]
  v_pk_add_f32 v[88:89], v[88:89], v[72:73]
  v_pk_add_f32 v[90:91], v[90:91], v[74:75]
  v_pk_add_f32 v[92:93], v[92:93], v[76:77]
  v_pk_add_f32 v[94:95], v[94:95], v[78:79]
  s_waitcnt lgkmcnt(0)
  v_pk_add_f32 v[80:81], v[80:81], v[96:97]
  v_pk_add_f32 v[82:83], v[82:83], v[98:99]
  v_pk_add_f32 v[84:85], v[84:85], v[100:101]
  v_pk_add_f32 v[86:87], v[86:87], v[102:103]
  v_pk_add_f32 v[88:89], v[88:89], v[104:105]
  v_pk_add_f32 v[90:91], v[90:91], v[106:107]
  v_pk_add_f32 v[92:93], v[92:93], v[108:109]
  v_pk_add_f32 v[94:95], v[94:95], v[110:111]
  v_cvt_pk_bf16_f32 v16, v80, v81
  v_lshlrev_b32 v80, 16, v16
  v_and_b32 v81, s91, v16
  v_cvt_pk_bf16_f32 v17, v82, v83
  v_lshlrev_b32 v82, 16, v17
  v_and_b32 v83, s91, v17
  v_cvt_pk_bf16_f32 v18, v84, v85
  v_lshlrev_b32 v84, 16, v18
  v_and_b32 v85, s91, v18
  v_cvt_pk_bf16_f32 v19, v86, v87
  v_lshlrev_b32 v86, 16, v19
  v_and_b32 v87, s91, v19
  v_pk_add_f32 v[80:81], v[80:81], v[32:33]
  v_pk_add_f32 v[82:83], v[82:83], v[34:35]
  v_pk_add_f32 v[84:85], v[84:85], v[36:37]
  v_pk_add_f32 v[86:87], v[86:87], v[38:39]
  v_cvt_pk_bf16_f32 v16, v80, v81
  v_cvt_pk_bf16_f32 v17, v82, v83
  v_cvt_pk_bf16_f32 v18, v84, v85
  v_cvt_pk_bf16_f32 v19, v86, v87
  s_nop 0
  v_permlane32_swap_b32 v16, v18
  v_permlane32_swap_b32 v17, v19
  buffer_store_dwordx4 v[16:19], v11, s[4:7], s85 offen offset:0
  v_cvt_pk_bf16_f32 v20, v88, v89
  v_lshlrev_b32 v88, 16, v20
  v_and_b32 v89, s91, v20
  v_cvt_pk_bf16_f32 v21, v90, v91
  v_lshlrev_b32 v90, 16, v21
  v_and_b32 v91, s91, v21
  v_cvt_pk_bf16_f32 v22, v92, v93
  v_lshlrev_b32 v92, 16, v22
  v_and_b32 v93, s91, v22
  v_cvt_pk_bf16_f32 v23, v94, v95
  v_lshlrev_b32 v94, 16, v23
  v_and_b32 v95, s91, v23
  v_pk_add_f32 v[88:89], v[88:89], v[40:41]
  v_pk_add_f32 v[90:91], v[90:91], v[42:43]
  v_pk_add_f32 v[92:93], v[92:93], v[44:45]
  v_pk_add_f32 v[94:95], v[94:95], v[46:47]
  v_cvt_pk_bf16_f32 v20, v88, v89
  v_cvt_pk_bf16_f32 v21, v90, v91
  v_cvt_pk_bf16_f32 v22, v92, v93
  v_cvt_pk_bf16_f32 v23, v94, v95
  s_nop 0
  v_permlane32_swap_b32 v20, v22
  v_permlane32_swap_b32 v21, v23
  buffer_store_dwordx4 v[20:23], v11, s[4:7], s85 offen offset:32
  s_branch G2_end
G2_v3:
  v_mfma_f32_32x32x16_bf16 v[64:79], a[192:195], v[208:211], v[64:79]
  v_mfma_f32_32x32x16_bf16 v[96:111], a[196:199], v[208:211], v[96:111]
  ds_read_b64_tr_b16 v[16:17], v246 offset:0
  ds_read_b64_tr_b16 v[18:19], v246 offset:1024
  ds_read_b64_tr_b16 v[20:21], v246 offset:2048
  ds_read_b64_tr_b16 v[22:23], v246 offset:3072
  v_mfma_f32_32x32x16_bf16 v[64:79], a[200:203], v[216:219], v[64:79]
  v_mfma_f32_32x32x16_bf16 v[96:111], a[204:207], v[216:219], v[96:111]
  v_mfma_f32_32x32x16_bf16 v[64:79], a[208:211], v[224:227], v[64:79]
  v_mfma_f32_32x32x16_bf16 v[96:111], a[212:215], v[224:227], v[96:111]
  v_mfma_f32_32x32x16_bf16 v[64:79], a[216:219], v[232:235], v[64:79]
  v_mfma_f32_32x32x16_bf16 v[96:111], a[220:223], v[232:235], v[96:111]
  v_mfma_f32_32x32x16_bf16 v[80:95], a[192:195], v[212:215], v[80:95]
  s_waitcnt lgkmcnt(0)
  v_lshlrev_b32 v32, 16, v16
  v_and_b32 v33, s91, v16
  v_lshlrev_b32 v34, 16, v17
  v_and_b32 v35, s91, v17
  v_mfma_f32_32x32x16_bf16 v[112:127], a[196:199], v[212:215], v[112:127]
  v_lshlrev_b32 v36, 16, v18
  v_and_b32 v37, s91, v18
  v_lshlrev_b32 v38, 16, v19
  v_and_b32 v39, s91, v19
  v_mfma_f32_32x32x16_bf16 v[80:95], a[200:203], v[220:223], v[80:95]
  ds_write_b128 v9, v[64:67] offset:0
  ds_write_b128 v9, v[68:71] offset:1024
  v_mfma_f32_32x32x16_bf16 v[112:127], a[204:207], v[220:223], v[112:127]
  ds_write_b128 v9, v[72:75] offset:2048
  ds_write_b128 v9, v[76:79] offset:3072
  v_mfma_f32_32x32x16_bf16 v[80:95], a[208:211], v[228:231], v[80:95]
  ds_write_b128 v9, v[96:99] offset:4096
  ds_write_b128 v9, v[100:103] offset:5120
  v_mfma_f32_32x32x16_bf16 v[112:127], a[212:215], v[228:231], v[112:127]
  ds_write_b128 v9, v[104:107] offset:6144
  ds_write_b128 v9, v[108:111] offset:7168
  v_mfma_f32_32x32x16_bf16 v[80:95], a[216:219], v[236:239], v[80:95]
  v_mfma_f32_32x32x16_bf16 v[112:127], a[220:223], v[236:239], v[112:127]
  v_lshlrev_b32 v40, 16, v20
  v_and_b32 v41, s91, v20
  v_lshlrev_b32 v42, 16, v21
  v_and_b32 v43, s91, v21
  v_lshlrev_b32 v44, 16, v22
  v_and_b32 v45, s91, v22
  v_lshlrev_b32 v46, 16, v23
  v_and_b32 v47, s91, v23
  s_nop 2
  ds_write_b128 v9, v[80:83] offset:8192
  ds_write_b128 v9, v[84:87] offset:9216
  ds_write_b128 v9, v[88:91] offset:10240
  ds_write_b128 v9, v[92:95] offset:11264
  s_waitcnt lgkmcnt(0)
  s_barrier
  ds_read_b128 v[64:67], v4 offset:0
  ds_read_b128 v[68:71], v4 offset:1024
  ds_read_b128 v[72:75], v4 offset:2048
  ds_read_b128 v[76:79], v4 offset:3072
  ds_read_b128 v[96:99], v5 offset:0
  ds_read_b128 v[100:103], v5 offset:1024
  ds_read_b128 v[104:107], v5 offset:2048
  ds_read_b128 v[108:111], v5 offset:3072
  ds_read_b128 v[80:83], v6 offset:0
  ds_read_b128 v[84:87], v6 offset:1024
  ds_read_b128 v[88:91], v6 offset:2048
  ds_read_b128 v[92:95], v6 offset:3072
  s_waitcnt lgkmcnt(8)
  v_pk_add_f32 v[112:113], v[112:113], v[64:65]
  v_pk_add_f32 v[114:115], v[114:115], v[66:67]
  v_pk_add_f32 v[116:117], v[116:117], v[68:69]
  v_pk_add_f32 v[118:119], v[118:119], v[70:71]
  v_pk_add_f32 v[120:121], v[120:121], v[72:73]
  v_pk_add_f32 v[122:123], v[122:123], v[74:75]
  v_pk_add_f32 v[124:125], v[124:125], v[76:77]
  v_pk_add_f32 v[126:127], v[126:127], v[78:79]
  s_waitcnt lgkmcnt(4)
  v_pk_add_f32 v[112:113], v[112:113], v[96:97]
  v_pk_add_f32 v[114:115], v[114:115], v[98:99]
  v_pk_add_f32 v[116:117], v[116:117], v[100:101]
  v_pk_add_f32 v[118:119], v[118:119], v[102:103]
  v_pk_add_f32 v[120:121], v[120:121], v[104:105]
  v_pk_add_f32 v[122:123], v[122:123], v[106:107]
  v_pk_add_f32 v[124:125], v[124:125], v[108:109]
  v_pk_add_f32 v[126:127], v[126:127], v[110:111]
  s_waitcnt lgkmcnt(0)
  v_pk_add_f32 v[112:113], v[112:113], v[80:81]
  v_pk_add_f32 v[114:115], v[114:115], v[82:83]
  v_pk_add_f32 v[116:117], v[116:117], v[84:85]
  v_pk_add_f32 v[118:119], v[118:119], v[86:87]
  v_pk_add_f32 v[120:121], v[120:121], v[88:89]
  v_pk_add_f32 v[122:123], v[122:123], v[90:91]
  v_pk_add_f32 v[124:125], v[124:125], v[92:93]
  v_pk_add_f32 v[126:127], v[126:127], v[94:95]
  v_cvt_pk_bf16_f32 v16, v112, v113
  v_lshlrev_b32 v112, 16, v16
  v_and_b32 v113, s91, v16
  v_cvt_pk_bf16_f32 v17, v114, v115
  v_lshlrev_b32 v114, 16, v17
  v_and_b32 v115, s91, v17
  v_cvt_pk_bf16_f32 v18, v116, v117
  v_lshlrev_b32 v116, 16, v18
  v_and_b32 v117, s91, v18
  v_cvt_pk_bf16_f32 v19, v118, v119
  v_lshlrev_b32 v118, 16, v19
  v_and_b32 v119, s91, v19
  v_pk_add_f32 v[112:113], v[112:113], v[32:33]
  v_pk_add_f32 v[114:115], v[114:115], v[34:35]
  v_pk_add_f32 v[116:117], v[116:117], v[36:37]
  v_pk_add_f32 v[118:119], v[118:119], v[38:39]
  v_cvt_pk_bf16_f32 v16, v112, v113
  v_cvt_pk_bf16_f32 v17, v114, v115
  v_cvt_pk_bf16_f32 v18, v116, v117
  v_cvt_pk_bf16_f32 v19, v118, v119
  s_nop 0
  v_permlane32_swap_b32 v16, v18
  v_permlane32_swap_b32 v17, v19
  buffer_store_dwordx4 v[16:19], v11, s[4:7], s85 offen offset:0
  v_cvt_pk_bf16_f32 v20, v120, v121
  v_lshlrev_b32 v120, 16, v20
  v_and_b32 v121, s91, v20
  v_cvt_pk_bf16_f32 v21, v122, v123
  v_lshlrev_b32 v122, 16, v21
  v_and_b32 v123, s91, v21
  v_cvt_pk_bf16_f32 v22, v124, v125
  v_lshlrev_b32 v124, 16, v22
  v_and_b32 v125, s91, v22
  v_cvt_pk_bf16_f32 v23, v126, v127
  v_lshlrev_b32 v126, 16, v23
  v_and_b32 v127, s91, v23
  v_pk_add_f32 v[120:121], v[120:121], v[40:41]
  v_pk_add_f32 v[122:123], v[122:123], v[42:43]
  v_pk_add_f32 v[124:125], v[124:125], v[44:45]
  v_pk_add_f32 v[126:127], v[126:127], v[46:47]
  v_cvt_pk_bf16_f32 v20, v120, v121
  v_cvt_pk_bf16_f32 v21, v122, v123
  v_cvt_pk_bf16_f32 v22, v124, v125
  v_cvt_pk_bf16_f32 v23, v126, v127
  s_nop 0
  v_permlane32_swap_b32 v20, v22
  v_permlane32_swap_b32 v21, v23
  buffer_store_dwordx4 v[20:23], v11, s[4:7], s85 offen offset:32
G2_end:
  s_waitcnt vmcnt(0)
  s_endpgm
SP_entry:
  s_mov_b32 s4, s36
  s_mov_b32 s5, s37
  s_mov_b32 s6, 1835008
  s_mov_b32 s7, 0x20000
  s_lshl_b32 s80, s2, 2
  s_add_u32 s80, s80, s28
  s_mul_i32 s80, s80, 1792
  v_and_b32 v216, 63, v0
  v_cmp_gt_u32 vcc, 56, v216
  v_lshlrev_b32 v216, 4, v216
  v_mov_b32 v217, 1073741824
  v_cndmask_b32 v216, v217, v216, vcc
  buffer_load_dwordx4 v[208:211], v216, s[4:7], s80 offen
  buffer_load_dwordx4 v[212:215], v216, s[4:7], s80 offen offset:896
  s_mov_b32 s24, s54
  s_mov_b32 s25, s55
  s_mov_b32 s26, 1605632
  s_mov_b32 s27, 0x20000
  s_add_u32 s12, s60, 4194304
  s_addc_u32 s13, s61, 0
  s_mov_b32 s14, 1835008
  s_mov_b32 s15, 0x20000
  s_sub_u32 s34, s2, 224
  v_mov_b32 v247, 0
  s_cmp_ge_u32 s34, 28
  s_cbranch_scc1 SP_a
  v_and_b32 v8, 63, v0
  v_lshrrev_b32 v9, 3, v8
  v_and_b32 v10, 7, v8
  v_bfe_u32 v11, v9, 1, 1
  v_lshlrev_b32 v11, 2, v11
  v_xor_b32 v10, v10, v11
  v_lshlrev_b32 v10, 4, v10
  v_mul_u32_u24 v242, 896, v9
  v_add_u32 v242, v242, v10
  v_lshlrev_b32 v247, 4, v8
  s_and_b32 s80, s34, 3
  s_mul_i32 s75, s80, 401408
  s_lshr_b32 s80, s34, 2
  s_lshl_b32 s80, s80, 7
  s_add_u32 s75, s75, s80
  s_mul_i32 s80, s28, 100352
  s_add_u32 s75, s75, s80
  s_lshl_b32 s77, s28, 14
  s_add_u32 s77, s77, 32768
  s_lshl_b32 s76, s34, 2
  s_add_u32 s76, s76, s28
  s_mul_i32 s76, s76, 14336
  v_bfe_u32 v9, v8, 2, 2
  v_lshrrev_b32 v10, 5, v8
  v_lshl_add_u32 v10, v10, 2, v9
  v_lshlrev_b32 v10, 7, v10
  v_bfe_u32 v11, v8, 4, 1
  v_lshl_add_u32 v10, v11, 5, v10
  v_and_b32 v11, 3, v8
  v_lshl_add_u32 v10, v11, 3, v10
  v_lshrrev_b32 v9, 1, v9
  v_lshl_add_u32 v244, v9, 6, v10
  v_xor_b32 v245, 64, v244
  v_add_u32 v244, s77, v244
  v_add_u32 v245, s77, v245
  s_add_u32 m0, s77, 0
  s_add_u32 s86, s75, 0
  buffer_load_dwordx4 v242, s[24:27], s86 offen lds
  s_add_u32 m0, s77, 1024
  s_add_u32 s86, s75, 7168
  buffer_load_dwordx4 v242, s[24:27], s86 offen lds
  s_add_u32 m0, s77, 2048
  s_add_u32 s86, s75, 14336
  buffer_load_dwordx4 v242, s[24:27], s86 offen lds
  s_add_u32 m0, s77, 3072
  s_add_u32 s86, s75, 21504
  buffer_load_dwordx4 v242, s[24:27], s86 offen lds
  s_add_u32 m0, s77, 4096
  s_add_u32 s86, s75, 28672
  buffer_load_dwordx4 v242, s[24:27], s86 offen lds
  s_add_u32 m0, s77, 5120
  s_add_u32 s86, s75, 35840
  buffer_load_dwordx4 v242, s[24:27], s86 offen lds
  s_add_u32 m0, s77, 6144
  s_add_u32 s86, s75, 43008
  buffer_load_dwordx4 v242, s[24:27], s86 offen lds
  s_add_u32 m0, s77, 7168
  s_add_u32 s86, s75, 50176
  buffer_load_dwordx4 v242, s[24:27], s86 offen lds
  s_add_u32 m0, s77, 8192
  s_add_u32 s86, s75, 57344
  buffer_load_dwordx4 v242, s[24:27], s86 offen lds
  s_add_u32 m0, s77, 9216
  s_add_u32 s86, s75, 64512
  buffer_load_dwordx4 v242, s[24:27], s86 offen lds
  s_add_u32 m0, s77, 10240
  s_add_u32 s86, s75, 71680
  buffer_load_dwordx4 v242, s[24:27], s86 offen lds
  s_add_u32 m0, s77, 11264
  s_add_u32 s86, s75, 78848
  buffer_load_dwordx4 v242, s[24:27], s86 offen lds
  s_add_u32 m0, s77, 12288
  s_add_u32 s86, s75, 86016
  buffer_load_dwordx4 v242, s[24:27], s86 offen lds
  s_add_u32 m0, s77, 13312
  s_add_u32 s86, s75, 93184
  buffer_load_dwordx4 v242, s[24:27], s86 offen lds
  s_waitcnt vmcnt(14)
  s_branch SP_a2
SP_a:
  s_waitcnt vmcnt(0)
SP_a2:
  s_waitcnt lgkmcnt(0)
  s_mul_i32 s29, s29, 0x9E3779B1
  s_add_u32 s29, s29, 0x7F4A7C15
  v_mov_b32 v216, 0
  v_mov_b32 v217, 0
  v_mov_b32 v218, 0
  v_mov_b32 v219, 0
  v_dot2_f32_bf16 v216, v208, s90, v216
  v_dot2_f32_bf16 v217, v212, s90, v217
  v_dot2_f32_bf16 v218, v208, v208, v218
  v_dot2_f32_bf16 v219, v212, v212, v219
  v_dot2_f32_bf16 v216, v209, s90, v216
  v_dot2_f32_bf16 v217, v213, s90, v217
  v_dot2_f32_bf16 v218, v209, v209, v218
  v_dot2_f32_bf16 v219, v213, v213, v219
  v_dot2_f32_bf16 v216, v210, s90, v216
  v_dot2_f32_bf16 v217, v214, s90, v217
  v_dot2_f32_bf16 v218, v210, v210, v218
  v_dot2_f32_bf16 v219, v214, v214, v219
  v_dot2_f32_bf16 v216, v211, s90, v216
  v_dot2_f32_bf16 v217, v215, s90, v217
  v_dot2_f32_bf16 v218, v211, v211, v218
  v_dot2_f32_bf16 v219, v215, v215, v219
  v_add_f32_dpp v216, v216, v216 row_ror:8 row_mask:0xf bank_mask:0xf
  v_add_f32_dpp v217, v217, v217 row_ror:8 row_mask:0xf bank_mask:0xf
  v_add_f32_dpp v218, v218, v218 row_ror:8 row_mask:0xf bank_mask:0xf
  v_add_f32_dpp v219, v219, v219 row_ror:8 row_mask:0xf bank_mask:0xf
  v_add_f32_dpp v216, v216, v216 row_ror:4 row_mask:0xf bank_mask:0xf
  v_add_f32_dpp v217, v217, v217 row_ror:4 row_mask:0xf bank_mask:0xf
  v_add_f32_dpp v218, v218, v218 row_ror:4 row_mask:0xf bank_mask:0xf
  v_add_f32_dpp v219, v219, v219 row_ror:4 row_mask:0xf bank_mask:0xf
  v_add_f32_dpp v216, v216, v216 row_ror:2 row_mask:0xf bank_mask:0xf
  v_add_f32_dpp v217, v217, v217 row_ror:2 row_mask:0xf bank_mask:0xf
  v_add_f32_dpp v218, v218, v218 row_ror:2 row_mask:0xf bank_mask:0xf
  v_add_f32_dpp v219, v219, v219 row_ror:2 row_mask:0xf bank_mask:0xf
  v_add_f32_dpp v216, v216, v216 row_ror:1 row_mask:0xf bank_mask:0xf
  v_add_f32_dpp v217, v217, v217 row_ror:1 row_mask:0xf bank_mask:0xf
  v_add_f32_dpp v218, v218, v218 row_ror:1 row_mask:0xf bank_mask:0xf
  v_add_f32_dpp v219, v219, v219 row_ror:1 row_mask:0xf bank_mask:0xf
  v_mov_b32 v220, v216
  v_mov_b32 v221, v217
  v_mov_b32 v222, v218
  v_mov_b32 v223, v219
  v_permlane16_swap_b32 v220, v216
  v_permlane16_swap_b32 v221, v217
  v_permlane16_swap_b32 v222, v218
  v_permlane16_swap_b32 v223, v219
  v_add_f32 v216, v216, v220
  v_add_f32 v217, v217, v221
  v_add_f32 v218, v218, v222
  v_add_f32 v219, v219, v223
  v_mov_b32 v220, v216
  v_mov_b32 v221, v217
  v_mov_b32 v222, v218
  v_mov_b32 v223, v219
  v_permlane32_swap_b32 v220, v216
  v_permlane32_swap_b32 v221, v217
  v_permlane32_swap_b32 v222, v218
  v_permlane32_swap_b32 v223, v219
  v_add_f32 v216, v216, v220
  v_add_f32 v217, v217, v221
  v_add_f32 v218, v218, v222
  v_add_f32 v219, v219, v223
  s_mov_b32 s88, 0x3b124925
  s_mov_b32 s89, 0x3727c5ac
  v_mul_f32 v216, s88, v216
  v_mul_f32 v217, s88, v217
  v_mul_f32 v218, s88, v218
  v_mul_f32 v219, s88, v219
  v_fma_f32 v218, -v216, v216, v218
  v_fma_f32 v219, -v217, v217, v219
  v_max_f32 v218, 0, v218
  v_max_f32 v219, 0, v219
  v_cvt_pk_bf16_f32 v222, v216, v217
  v_lshlrev_b32 v208, 16, v222
  v_and_b32 v209, s91, v222
  v_cvt_pk_bf16_f32 v222, v218, v219
  v_lshlrev_b32 v220, 16, v222
  v_and_b32 v221, s91, v222
  v_add_f32 v220, s89, v220
  v_add_f32 v221, s89, v221
  v_cvt_pk_bf16_f32 v222, v220, v221
  v_lshlrev_b32 v220, 16, v222
  v_and_b32 v221, s91, v222
  v_sqrt_f32 v220, v220
  v_sqrt_f32 v221, v221
  s_nop 0
  v_cvt_pk_bf16_f32 v222, v220, v221
  v_lshlrev_b32 v220, 16, v222
  v_and_b32 v221, s91, v222
  s_lshl_b32 s80, s2, 2
  s_add_u32 s80, s80, s28
  s_lshl_b32 s80, s80, 4
  s_add_u32 s80, s80, 15728640
  v_lshrrev_b32 v208, 16, v208
  v_or_b32 v212, v208, v220
  v_lshrrev_b32 v209, 16, v209
  v_or_b32 v213, v209, v221
  v_mov_b32 v214, s29
  v_mov_b32 v215, 0
  v_mov_b32 v216, 0
  s_mov_b64 exec, 1
  buffer_store_dwordx4 v[212:215], v216, s[8:11], s80 offen sc1
  s_mov_b64 exec, -1
  s_cmp_ge_u32 s34, 28
  s_cbranch_scc1 SP_h
  s_waitcnt vmcnt(0)
  ds_read_b64_tr_b16 v[8:9], v244 offset:0
  ds_read_b64_tr_b16 v[10:11], v244 offset:1024
  ds_read_b64_tr_b16 v[12:13], v245 offset:0
  ds_read_b64_tr_b16 v[14:15], v245 offset:1024
  ds_read_b64_tr_b16 v[16:17], v244 offset:2048
  ds_read_b64_tr_b16 v[18:19], v244 offset:3072
  ds_read_b64_tr_b16 v[20:21], v245 offset:2048
  ds_read_b64_tr_b16 v[22:23], v245 offset:3072
  ds_read_b64_tr_b16 v[24:25], v244 offset:4096
  ds_read_b64_tr_b16 v[26:27], v244 offset:5120
  ds_read_b64_tr_b16 v[28:29], v245 offset:4096
  ds_read_b64_tr_b16 v[30:31], v245 offset:5120
  ds_read_b64_tr_b16 v[32:33], v244 offset:6144
  ds_read_b64_tr_b16 v[34:35], v244 offset:7168
  ds_read_b64_tr_b16 v[36:37], v245 offset:6144
  ds_read_b64_tr_b16 v[38:39], v245 offset:7168
  ds_read_b64_tr_b16 v[40:41], v244 offset:8192
  ds_read_b64_tr_b16 v[42:43], v244 offset:9216
  ds_read_b64_tr_b16 v[44:45], v245 offset:8192
  ds_read_b64_tr_b16 v[46:47], v245 offset:9216
  ds_read_b64_tr_b16 v[48:49], v244 offset:10240
  ds_read_b64_tr_b16 v[50:51], v244 offset:11264
  ds_read_b64_tr_b16 v[52:53], v245 offset:10240
  ds_read_b64_tr_b16 v[54:55], v245 offset:11264
  ds_read_b64_tr_b16 v[56:57], v244 offset:12288
  ds_read_b64_tr_b16 v[58:59], v244 offset:13312
  ds_read_b64_tr_b16 v[60:61], v245 offset:12288
  ds_read_b64_tr_b16 v[62:63], v245 offset:13312
  s_waitcnt lgkmcnt(0)
  buffer_store_dwordx4 v[8:11], v247, s[8:11], s76 offen offset:0 sc1
  buffer_store_dwordx4 v[12:15], v247, s[8:11], s76 offen offset:1024 sc1
  s_add_u32 s76, s76, 2048
  buffer_store_dwordx4 v[16:19], v247, s[8:11], s76 offen offset:0 sc1
  buffer_store_dwordx4 v[20:23], v247, s[8:11], s76 offen offset:1024 sc1
  s_add_u32 s76, s76, 2048
  buffer_store_dwordx4 v[24:27], v247, s[8:11], s76 offen offset:0 sc1
  buffer_store_dwordx4 v[28:31], v247, s[8:11], s76 offen offset:1024 sc1
  s_add_u32 s76, s76, 2048
  buffer_store_dwordx4 v[32:35], v247, s[8:11], s76 offen offset:0 sc1
  buffer_store_dwordx4 v[36:39], v247, s[8:11], s76 offen offset:1024 sc1
  s_add_u32 s76, s76, 2048
  buffer_store_dwordx4 v[40:43], v247, s[8:11], s76 offen offset:0 sc1
  buffer_store_dwordx4 v[44:47], v247, s[8:11], s76 offen offset:1024 sc1
  s_add_u32 s76, s76, 2048
  buffer_store_dwordx4 v[48:51], v247, s[8:11], s76 offen offset:0 sc1
  buffer_store_dwordx4 v[52:55], v247, s[8:11], s76 offen offset:1024 sc1
  s_add_u32 s76, s76, 2048
  buffer_store_dwordx4 v[56:59], v247, s[8:11], s76 offen offset:0 sc1
  buffer_store_dwordx4 v[60:63], v247, s[8:11], s76 offen offset:1024 sc1
  s_add_u32 s76, s76, 2048
  s_lshl_b32 s87, s34, 7
  s_add_u32 s87, s87, 15761408
  s_waitcnt vmcnt(0)
  s_barrier
  s_cmp_lg_u32 s28, 0
  s_cbranch_scc1 SP_b
  v_mov_b32 v8, 0
  v_mov_b32 v9, s29
  s_mov_b64 exec, 1
  buffer_store_dword v9, v8, s[8:11], s87 offen sc1
  s_mov_b64 exec, -1
SP_b:
  v_and_b32 v1, 7, v0
  v_lshrrev_b32 v2, 3, v0
  v_mul_u32_u24 v2, 3584, v2
  v_lshl_add_u32 v2, v1, 4, v2
  s_lshl_b32 s80, s34, 7
  buffer_load_dwordx4 v[8:11], v2, s[20:23], s80 offen
  s_add_u32 s80, s80, 114688
  buffer_load_dwordx4 v[12:15], v2, s[20:23], s80 offen
  s_add_u32 s80, s80, 114688
  buffer_load_dwordx4 v[16:19], v2, s[20:23], s80 offen
  s_add_u32 s80, s80, 114688
  buffer_load_dwordx4 v[20:23], v2, s[20:23], s80 offen
  s_add_u32 s80, s80, 114688
  buffer_load_dwordx4 v[24:27], v2, s[20:23], s80 offen
  s_add_u32 s80, s80, 114688
  buffer_load_dwordx4 v[28:31], v2, s[20:23], s80 offen
  s_add_u32 s80, s80, 114688
  buffer_load_dwordx4 v[32:35], v2, s[20:23], s80 offen
  s_add_u32 s80, s80, 114688
  buffer_load_dwordx4 v[36:39], v2, s[20:23], s80 offen
  s_add_u32 s80, s80, 114688
  buffer_load_dwordx4 v[40:43], v2, s[20:23], s80 offen
  s_add_u32 s80, s80, 114688
  buffer_load_dwordx4 v[44:47], v2, s[20:23], s80 offen
  s_add_u32 s80, s80, 114688
  buffer_load_dwordx4 v[48:51], v2, s[20:23], s80 offen
  s_add_u32 s80, s80, 114688
  buffer_load_dwordx4 v[52:55], v2, s[20:23], s80 offen
  s_add_u32 s80, s80, 114688
  buffer_load_dwordx4 v[56:59], v2, s[20:23], s80 offen
  s_add_u32 s80, s80, 114688
  buffer_load_dwordx4 v[60:63], v2, s[20:23], s80 offen
  s_add_u32 s80, s80, 114688
  s_mov_b32 s84, 0x00003f80
  s_mov_b32 s85, 0x3f800000
  v_mov_b32 v70, 0
  v_mov_b32 v71, 0
  v_mov_b32 v72, 0
  v_mov_b32 v73, 0
  v_mov_b32 v74, 0
  v_mov_b32 v75, 0
  v_mov_b32 v76, 0
  v_mov_b32 v77, 0
  s_waitcnt vmcnt(13)
  v_dot2_f32_bf16 v70, v8, s84, v70
  v_dot2_f32_bf16 v71, v8, s85, v71
  v_dot2_f32_bf16 v72, v9, s84, v72
  v_dot2_f32_bf16 v73, v9, s85, v73
  v_dot2_f32_bf16 v74, v10, s84, v74
  v_dot2_f32_bf16 v75, v10, s85, v75
  v_dot2_f32_bf16 v76, v11, s84, v76
  v_dot2_f32_bf16 v77, v11, s85, v77
  s_waitcnt vmcnt(12)
  v_dot2_f32_bf16 v70, v12, s84, v70
  v_dot2_f32_bf16 v71, v12, s85, v71
  v_dot2_f32_bf16 v72, v13, s84, v72
  v_dot2_f32_bf16 v73, v13, s85, v73
  v_dot2_f32_bf16 v74, v14, s84, v74
  v_dot2_f32_bf16 v75, v14, s85, v75
  v_dot2_f32_bf16 v76, v15, s84, v76
  v_dot2_f32_bf16 v77, v15, s85, v77
  s_waitcnt vmcnt(11)
  v_dot2_f32_bf16 v70, v16, s84, v70
  v_dot2_f32_bf16 v71, v16, s85, v71
  v_dot2_f32_bf16 v72, v17, s84, v72
  v_dot2_f32_bf16 v73, v17, s85, v73
  v_dot2_f32_bf16 v74, v18, s84, v74
  v_dot2_f32_bf16 v75, v18, s85, v75
  v_dot2_f32_bf16 v76, v19, s84, v76
  v_dot2_f32_bf16 v77, v19, s85, v77
  s_waitcnt vmcnt(10)
  v_dot2_f32_bf16 v70, v20, s84, v70
  v_dot2_f32_bf16 v71, v20, s85, v71
  v_dot2_f32_bf16 v72, v21, s84, v72
  v_dot2_f32_bf16 v73, v21, s85, v73
  v_dot2_f32_bf16 v74, v22, s84, v74
  v_dot2_f32_bf16 v75, v22, s85, v75
  v_dot2_f32_bf16 v76, v23, s84, v76
  v_dot2_f32_bf16 v77, v23, s85, v77
  s_waitcnt vmcnt(9)
  v_dot2_f32_bf16 v70, v24, s84, v70
  v_dot2_f32_bf16 v71, v24, s85, v71
  v_dot2_f32_bf16 v72, v25, s84, v72
  v_dot2_f32_bf16 v73, v25, s85, v73
  v_dot2_f32_bf16 v74, v26, s84, v74
  v_dot2_f32_bf16 v75, v26, s85, v75
  v_dot2_f32_bf16 v76, v27, s84, v76
  v_dot2_f32_bf16 v77, v27, s85, v77
  s_waitcnt vmcnt(8)
  v_dot2_f32_bf16 v70, v28, s84, v70
  v_dot2_f32_bf16 v71, v28, s85, v71
  v_dot2_f32_bf16 v72, v29, s84, v72
  v_dot2_f32_bf16 v73, v29, s85, v73
  v_dot2_f32_bf16 v74, v30, s84, v74
  v_dot2_f32_bf16 v75, v30, s85, v75
  v_dot2_f32_bf16 v76, v31, s84, v76
  v_dot2_f32_bf16 v77, v31, s85, v77
  s_waitcnt vmcnt(7)
  v_dot2_f32_bf16 v70, v32, s84, v70
  v_dot2_f32_bf16 v71, v32, s85, v71
  v_dot2_f32_bf16 v72, v33, s84, v72
  v_dot2_f32_bf16 v73, v33, s85, v73
  v_dot2_f32_bf16 v74, v34, s84, v74
  v_dot2_f32_bf16 v75, v34, s85, v75
  v_dot2_f32_bf16 v76, v35, s84, v76
  v_dot2_f32_bf16 v77, v35, s85, v77
  s_waitcnt vmcnt(6)
  v_dot2_f32_bf16 v70, v36, s84, v70
  v_dot2_f32_bf16 v71, v36, s85, v71
  v_dot2_f32_bf16 v72, v37, s84, v72
  v_dot2_f32_bf16 v73, v37, s85, v73
  v_dot2_f32_bf16 v74, v38, s84, v74
  v_dot2_f32_bf16 v75, v38, s85, v75
  v_dot2_f32_bf16 v76, v39, s84, v76
  v_dot2_f32_bf16 v77, v39, s85, v77
  s_waitcnt vmcnt(5)
  v_dot2_f32_bf16 v70, v40, s84, v70
  v_dot2_f32_bf16 v71, v40, s85, v71
  v_dot2_f32_bf16 v72, v41, s84, v72
  v_dot2_f32_bf16 v73, v41, s85, v73
  v_dot2_f32_bf16 v74, v42, s84, v74
  v_dot2_f32_bf16 v75, v42, s85, v75
  v_dot2_f32_bf16 v76, v43, s84, v76
  v_dot2_f32_bf16 v77, v43, s85, v77
  s_waitcnt vmcnt(4)
  v_dot2_f32_bf16 v70, v44, s84, v70
  v_dot2_f32_bf16 v71, v44, s85, v71
  v_dot2_f32_bf16 v72, v45, s84, v72
  v_dot2_f32_bf16 v73, v45, s85, v73
  v_dot2_f32_bf16 v74, v46, s84, v74
  v_dot2_f32_bf16 v75, v46, s85, v75
  v_dot2_f32_bf16 v76, v47, s84, v76
  v_dot2_f32_bf16 v77, v47, s85, v77
  s_waitcnt vmcnt(3)
  v_dot2_f32_bf16 v70, v48, s84, v70
  v_dot2_f32_bf16 v71, v48, s85, v71
  v_dot2_f32_bf16 v72, v49, s84, v72
  v_dot2_f32_bf16 v73, v49, s85, v73
  v_dot2_f32_bf16 v74, v50, s84, v74
  v_dot2_f32_bf16 v75, v50, s85, v75
  v_dot2_f32_bf16 v76, v51, s84, v76
  v_dot2_f32_bf16 v77, v51, s85, v77
  s_waitcnt vmcnt(2)
  v_dot2_f32_bf16 v70, v52, s84, v70
  v_dot2_f32_bf16 v71, v52, s85, v71
  v_dot2_f32_bf16 v72, v53, s84, v72
  v_dot2_f32_bf16 v73, v53, s85, v73
  v_dot2_f32_bf16 v74, v54, s84, v74
  v_dot2_f32_bf16 v75, v54, s85, v75
  v_dot2_f32_bf16 v76, v55, s84, v76
  v_dot2_f32_bf16 v77, v55, s85, v77
  s_waitcnt vmcnt(1)
  v_dot2_f32_bf16 v70, v56, s84, v70
  v_dot2_f32_bf16 v71, v56, s85, v71
  v_dot2_f32_bf16 v72, v57, s84, v72
  v_dot2_f32_bf16 v73, v57, s85, v73
  v_dot2_f32_bf16 v74, v58, s84, v74
  v_dot2_f32_bf16 v75, v58, s85, v75
  v_dot2_f32_bf16 v76, v59, s84, v76
  v_dot2_f32_bf16 v77, v59, s85, v77
  s_waitcnt vmcnt(0)
  v_dot2_f32_bf16 v70, v60, s84, v70
  v_dot2_f32_bf16 v71, v60, s85, v71
  v_dot2_f32_bf16 v72, v61, s84, v72
  v_dot2_f32_bf16 v73, v61, s85, v73
  v_dot2_f32_bf16 v74, v62, s84, v74
  v_dot2_f32_bf16 v75, v62, s85, v75
  v_dot2_f32_bf16 v76, v63, s84, v76
  v_dot2_f32_bf16 v77, v63, s85, v77
  v_lshrrev_b32 v2, 3, v0
  v_mul_u32_u24 v2, 272, v2
  v_lshl_add_u32 v2, v1, 5, v2
  s_nop 1
  ds_write_b128 v2, v[70:73]
  ds_write_b128 v2, v[74:77] offset:16
  v_and_b32 v1, 63, v0
  v_lshrrev_b32 v3, 6, v0
  v_mul_u32_u24 v2, 2176, v3
  v_lshl_add_u32 v2, v1, 2, v2
  s_waitcnt lgkmcnt(0)
  s_barrier
  ds_read_b32 v8, v2 offset:0
  ds_read_b32 v9, v2 offset:272
  ds_read_b32 v10, v2 offset:544
  ds_read_b32 v11, v2 offset:816
  ds_read_b32 v12, v2 offset:1088
  ds_read_b32 v13, v2 offset:1360
  ds_read_b32 v14, v2 offset:1632
  ds_read_b32 v15, v2 offset:1904
  s_waitcnt lgkmcnt(0)
  v_add_f32 v8, v8, v9
  v_add_f32 v10, v10, v11
  v_add_f32 v12, v12, v13
  v_add_f32 v14, v14, v15
  v_add_f32 v8, v8, v10
  v_add_f32 v12, v12, v14
  v_add_f32 v8, v8, v12
  v_lshlrev_b32 v2, 2, v0
  ds_write_b32 v2, v8 offset:16384
  v_lshlrev_b32 v2, 2, v1
  s_waitcnt lgkmcnt(0)
  s_barrier
  ds_read_b32 v8, v2 offset:16384
  ds_read_b32 v9, v2 offset:16640
  ds_read_b32 v10, v2 offset:16896
  ds_read_b32 v11, v2 offset:17152
  s_waitcnt lgkmcnt(0)
  v_add_f32 v8, v8, v9
  v_add_f32 v10, v10, v11
  v_add_f32 v8, v8, v10
  v_cvt_pk_bf16_f32 v9, v8, v8
  v_and_b32 v10, s91, v9
  v_sub_f32 v8, v8, v10
  v_cvt_pk_bf16_f32 v11, v8, v8
  v_and_b32 v12, s91, v11
  v_sub_f32 v8, v8, v12
  v_cvt_pk_bf16_f32 v15, v8, v8
  v_and_b32 v15, 0xffff, v15
  v_lshrrev_b32 v14, 16, v10
  v_or_b32 v14, v14, v12
  s_lshl_b32 s80, s34, 9
  s_add_u32 s80, s80, 14680064
  v_lshlrev_b32 v2, 3, v1
  v_cmp_gt_u32 vcc, 64, v0
  s_and_saveexec_b64 s[86:87], vcc
  buffer_store_dwordx2 v[14:15], v2, s[8:11], s80 offen sc1
  s_mov_b64 exec, s[86:87]
  s_lshl_b32 s87, s34, 3
  s_add_u32 s87, s87, 15826944
  s_cmp_lg_u32 s28, 0
  s_cbranch_scc1 SP_j
  s_waitcnt vmcnt(0)
  v_and_b32 v8, 63, v0
  v_mul_u32_u24 v8, 0, v8
  v_mov_b32 v10, s29
  v_mov_b32 v11, s29
  s_mov_b64 exec, 1
  buffer_store_dwordx2 v[10:11], v8, s[8:11], s87 offen sc1
  s_mov_b64 exec, -1
SP_h:
  s_cmp_lg_u32 s28, 0
  s_cbranch_scc1 SP_j
  v_and_b32 v1, 63, v0
  s_and_b32 s80, s2, 7
  s_mul_i32 s80, s80, 8192
  s_add_u32 s80, s80, 14745600
  v_min_u32 v1, 55, v1
  v_mul_u32_u24 v56, 32, v1
  s_add_u32 s81, s80, 0
  v_add_u32 v56, s81, v56
  v_mul_u32_u24 v57, 32, v1
  s_add_u32 s81, s80, 1792
  v_add_u32 v57, s81, v57
  v_mul_u32_u24 v58, 32, v1
  s_add_u32 s81, s80, 3584
  v_add_u32 v58, s81, v58
  v_mul_u32_u24 v59, 32, v1
  s_add_u32 s81, s80, 5376
  v_add_u32 v59, s81, v59
  s_mov_b32 s81, 0
  s_branch PS_go
PS_loop:
  s_sleep 2
PS_go:
  buffer_load_dword v32, v56, s[8:11], 0 offen sc1
  buffer_load_dword v33, v57, s[8:11], 0 offen sc1
  buffer_load_dword v34, v58, s[8:11], 0 offen sc1
  buffer_load_dword v35, v59, s[8:11], 0 offen sc1
  s_add_u32 s81, s81, 1
  s_cmp_ge_u32 s81, 100000
  s_cbranch_scc1 PS_done
  s_waitcnt vmcnt(0)
  v_cmp_ne_u32 vcc, s29, v32
  v_cmp_ne_u32 s[82:83], s29, v33
  s_or_b64 vcc, vcc, s[82:83]
  v_cmp_ne_u32 s[82:83], s29, v34
  s_or_b64 vcc, vcc, s[82:83]
  v_cmp_ne_u32 s[82:83], s29, v35
  s_or_b64 vcc, vcc, s[82:83]
  s_cbranch_vccnz PS_loop
PS_done:
SP_j:
  s_barrier
  v_and_b32 v1, 63, v0
  v_lshrrev_b32 v2, 3, v1
  v_and_b32 v3, 7, v1
  v_lshlrev_b32 v2, 8, v2
  v_lshl_add_u32 v2, v3, 4, v2
  s_lshr_b32 s80, s34, 1
  s_mul_i32 s80, s80, 114688
  s_and_b32 s81, s34, 1
  s_lshl_b32 s81, s81, 7
  s_add_u32 s80, s80, s81
  s_lshl_b32 s81, s28, 11
  s_add_u32 s80, s80, s81
  buffer_load_dwordx4 v[8:11], v2, s[12:15], s80 offen sc1
  s_add_u32 s80, s80, 8192
  buffer_load_dwordx4 v[12:15], v2, s[12:15], s80 offen sc1
  s_add_u32 s80, s80, 8192
  buffer_load_dwordx4 v[16:19], v2, s[12:15], s80 offen sc1
  s_add_u32 s80, s80, 8192
  buffer_load_dwordx4 v[20:23], v2, s[12:15], s80 offen sc1
  s_add_u32 s80, s80, 8192
  buffer_load_dwordx4 v[24:27], v2, s[12:15], s80 offen sc1
  s_add_u32 s80, s80, 8192
  buffer_load_dwordx4 v[28:31], v2, s[12:15], s80 offen sc1
  s_add_u32 s80, s80, 8192
  buffer_load_dwordx4 v[32:35], v2, s[12:15], s80 offen sc1
  s_add_u32 s80, s80, 8192
  buffer_load_dwordx4 v[36:39], v2, s[12:15], s80 offen sc1
  s_add_u32 s80, s80, 8192
  buffer_load_dwordx4 v[40:43], v2, s[12:15], s80 offen sc1
  s_add_u32 s80, s80, 8192
  buffer_load_dwordx4 v[44:47], v2, s[12:15], s80 offen sc1
  s_add_u32 s80, s80, 8192
  buffer_load_dwordx4 v[48:51], v2, s[12:15], s80 offen sc1
  s_add_u32 s80, s80, 8192
  buffer_load_dwordx4 v[52:55], v2, s[12:15], s80 offen sc1
  s_add_u32 s80, s80, 8192
  buffer_load_dwordx4 v[56:59], v2, s[12:15], s80 offen sc1
  s_add_u32 s80, s80, 8192
  buffer_load_dwordx4 v[60:63], v2, s[12:15], s80 offen sc1
  s_add_u32 s80, s80, 8192
  s_mov_b32 s84, 0x05040100
  s_mov_b32 s85, 0x07060302
  v_bfe_u32 v4, v1, 4, 1
  v_lshlrev_b32 v4, 4, v4
  v_lshl_add_u32 v4, v3, 5, v4
  v_lshrrev_b32 v5, 5, v1
  v_lshl_add_u32 v4, v5, 8, v4
  s_lshl_b32 s80, s28, 9
  v_add_u32 v4, s80, v4
  v_lshlrev_b32 v5, 2, v1
  s_waitcnt vmcnt(12)
  v_perm_b32 v64, v12, v8, s84
  v_perm_b32 v65, v12, v8, s85
  v_perm_b32 v66, v13, v9, s84
  v_perm_b32 v67, v13, v9, s85
  v_perm_b32 v68, v14, v10, s84
  v_perm_b32 v69, v14, v10, s85
  v_perm_b32 v70, v15, v11, s84
  v_perm_b32 v71, v15, v11, s85
  v_dot2_f32_bf16 v72, v64, s90, 0
  v_dot2_f32_bf16 v73, v65, s90, 0
  v_dot2_f32_bf16 v74, v66, s90, 0
  v_dot2_f32_bf16 v75, v67, s90, 0
  v_dot2_f32_bf16 v76, v68, s90, 0
  v_dot2_f32_bf16 v77, v69, s90, 0
  v_dot2_f32_bf16 v78, v70, s90, 0
  v_dot2_f32_bf16 v79, v71, s90, 0
  v_dot2_f32_bf16 v80, v64, v64, 0
  v_dot2_f32_bf16 v81, v65, v65, 0
  v_dot2_f32_bf16 v82, v66, v66, 0
  v_dot2_f32_bf16 v83, v67, v67, 0
  v_dot2_f32_bf16 v84, v68, v68, 0
  v_dot2_f32_bf16 v85, v69, v69, 0
  v_dot2_f32_bf16 v86, v70, v70, 0
  v_dot2_f32_bf16 v87, v71, v71, 0
  s_waitcnt vmcnt(10)
  v_perm_b32 v64, v20, v16, s84
  v_perm_b32 v65, v20, v16, s85
  v_perm_b32 v66, v21, v17, s84
  v_perm_b32 v67, v21, v17, s85
  v_perm_b32 v68, v22, v18, s84
  v_perm_b32 v69, v22, v18, s85
  v_perm_b32 v70, v23, v19, s84
  v_perm_b32 v71, v23, v19, s85
  v_dot2_f32_bf16 v72, v64, s90, v72
  v_dot2_f32_bf16 v73, v65, s90, v73
  v_dot2_f32_bf16 v74, v66, s90, v74
  v_dot2_f32_bf16 v75, v67, s90, v75
  v_dot2_f32_bf16 v76, v68, s90, v76
  v_dot2_f32_bf16 v77, v69, s90, v77
  v_dot2_f32_bf16 v78, v70, s90, v78
  v_dot2_f32_bf16 v79, v71, s90, v79
  v_dot2_f32_bf16 v80, v64, v64, v80
  v_dot2_f32_bf16 v81, v65, v65, v81
  v_dot2_f32_bf16 v82, v66, v66, v82
  v_dot2_f32_bf16 v83, v67, v67, v83
  v_dot2_f32_bf16 v84, v68, v68, v84
  v_dot2_f32_bf16 v85, v69, v69, v85
  v_dot2_f32_bf16 v86, v70, v70, v86
  v_dot2_f32_bf16 v87, v71, v71, v87
  s_waitcnt vmcnt(8)
  v_perm_b32 v64, v28, v24, s84
  v_perm_b32 v65, v28, v24, s85
  v_perm_b32 v66, v29, v25, s84
  v_perm_b32 v67, v29, v25, s85
  v_perm_b32 v68, v30, v26, s84
  v_perm_b32 v69, v30, v26, s85
  v_perm_b32 v70, v31, v27, s84
  v_perm_b32 v71, v31, v27, s85
  v_dot2_f32_bf16 v72, v64, s90, v72
  v_dot2_f32_bf16 v73, v65, s90, v73
  v_dot2_f32_bf16 v74, v66, s90, v74
  v_dot2_f32_bf16 v75, v67, s90, v75
  v_dot2_f32_bf16 v76, v68, s90, v76
  v_dot2_f32_bf16 v77, v69, s90, v77
  v_dot2_f32_bf16 v78, v70, s90, v78
  v_dot2_f32_bf16 v79, v71, s90, v79
  v_dot2_f32_bf16 v80, v64, v64, v80
  v_dot2_f32_bf16 v81, v65, v65, v81
  v_dot2_f32_bf16 v82, v66, v66, v82
  v_dot2_f32_bf16 v83, v67, v67, v83
  v_dot2_f32_bf16 v84, v68, v68, v84
  v_dot2_f32_bf16 v85, v69, v69, v85
  v_dot2_f32_bf16 v86, v70, v70, v86
  v_dot2_f32_bf16 v87, v71, v71, v87
  s_waitcnt vmcnt(6)
  v_perm_b32 v64, v36, v32, s84
  v_perm_b32 v65, v36, v32, s85
  v_perm_b32 v66, v37, v33, s84
  v_perm_b32 v67, v37, v33, s85
  v_perm_b32 v68, v38, v34, s84
  v_perm_b32 v69, v38, v34, s85
  v_perm_b32 v70, v39, v35, s84
  v_perm_b32 v71, v39, v35, s85
  v_dot2_f32_bf16 v72, v64, s90, v72
  v_dot2_f32_bf16 v73, v65, s90, v73
  v_dot2_f32_bf16 v74, v66, s90, v74
  v_dot2_f32_bf16 v75, v67, s90, v75
  v_dot2_f32_bf16 v76, v68, s90, v76
  v_dot2_f32_bf16 v77, v69, s90, v77
  v_dot2_f32_bf16 v78, v70, s90, v78
  v_dot2_f32_bf16 v79, v71, s90, v79
  v_dot2_f32_bf16 v80, v64, v64, v80
  v_dot2_f32_bf16 v81, v65, v65, v81
  v_dot2_f32_bf16 v82, v66, v66, v82
  v_dot2_f32_bf16 v83, v67, v67, v83
  v_dot2_f32_bf16 v84, v68, v68, v84
  v_dot2_f32_bf16 v85, v69, v69, v85
  v_dot2_f32_bf16 v86, v70, v70, v86
  v_dot2_f32_bf16 v87, v71, v71, v87
  s_waitcnt vmcnt(4)
  v_perm_b32 v64, v44, v40, s84
  v_perm_b32 v65, v44, v40, s85
  v_perm_b32 v66, v45, v41, s84
  v_perm_b32 v67, v45, v41, s85
  v_perm_b32 v68, v46, v42, s84
  v_perm_b32 v69, v46, v42, s85
  v_perm_b32 v70, v47, v43, s84
  v_perm_b32 v71, v47, v43, s85
  v_dot2_f32_bf16 v72, v64, s90, v72
  v_dot2_f32_bf16 v73, v65, s90, v73
  v_dot2_f32_bf16 v74, v66, s90, v74
  v_dot2_f32_bf16 v75, v67, s90, v75
  v_dot2_f32_bf16 v76, v68, s90, v76
  v_dot2_f32_bf16 v77, v69, s90, v77
  v_dot2_f32_bf16 v78, v70, s90, v78
  v_dot2_f32_bf16 v79, v71, s90, v79
  v_dot2_f32_bf16 v80, v64, v64, v80
  v_dot2_f32_bf16 v81, v65, v65, v81
  v_dot2_f32_bf16 v82, v66, v66, v82
  v_dot2_f32_bf16 v83, v67, v67, v83
  v_dot2_f32_bf16 v84, v68, v68, v84
  v_dot2_f32_bf16 v85, v69, v69, v85
  v_dot2_f32_bf16 v86, v70, v70, v86
  v_dot2_f32_bf16 v87, v71, v71, v87
  s_waitcnt vmcnt(2)
  v_perm_b32 v64, v52, v48, s84
  v_perm_b32 v65, v52, v48, s85
  v_perm_b32 v66, v53, v49, s84
  v_perm_b32 v67, v53, v49, s85
  v_perm_b32 v68, v54, v50, s84
  v_perm_b32 v69, v54, v50, s85
  v_perm_b32 v70, v55, v51, s84
  v_perm_b32 v71, v55, v51, s85
  v_dot2_f32_bf16 v72, v64, s90, v72
  v_dot2_f32_bf16 v73, v65, s90, v73
  v_dot2_f32_bf16 v74, v66, s90, v74
  v_dot2_f32_bf16 v75, v67, s90, v75
  v_dot2_f32_bf16 v76, v68, s90, v76
  v_dot2_f32_bf16 v77, v69, s90, v77
  v_dot2_f32_bf16 v78, v70, s90, v78
  v_dot2_f32_bf16 v79, v71, s90, v79
  v_dot2_f32_bf16 v80, v64, v64, v80
  v_dot2_f32_bf16 v81, v65, v65, v81
  v_dot2_f32_bf16 v82, v66, v66, v82
  v_dot2_f32_bf16 v83, v67, v67, v83
  v_dot2_f32_bf16 v84, v68, v68, v84
  v_dot2_f32_bf16 v85, v69, v69, v85
  v_dot2_f32_bf16 v86, v70, v70, v86
  v_dot2_f32_bf16 v87, v71, v71, v87
  s_waitcnt vmcnt(0)
  v_perm_b32 v64, v60, v56, s84
  v_perm_b32 v65, v60, v56, s85
  v_perm_b32 v66, v61, v57, s84
  v_perm_b32 v67, v61, v57, s85
  v_perm_b32 v68, v62, v58, s84
  v_perm_b32 v69, v62, v58, s85
  v_perm_b32 v70, v63, v59, s84
  v_perm_b32 v71, v63, v59, s85
  v_dot2_f32_bf16 v72, v64, s90, v72
  v_dot2_f32_bf16 v73, v65, s90, v73
  v_dot2_f32_bf16 v74, v66, s90, v74
  v_dot2_f32_bf16 v75, v67, s90, v75
  v_dot2_f32_bf16 v76, v68, s90, v76
  v_dot2_f32_bf16 v77, v69, s90, v77
  v_dot2_f32_bf16 v78, v70, s90, v78
  v_dot2_f32_bf16 v79, v71, s90, v79
  v_dot2_f32_bf16 v80, v64, v64, v80
  v_dot2_f32_bf16 v81, v65, v65, v81
  v_dot2_f32_bf16 v82, v66, v66, v82
  v_dot2_f32_bf16 v83, v67, v67, v83
  v_dot2_f32_bf16 v84, v68, v68, v84
  v_dot2_f32_bf16 v85, v69, v69, v85
  v_dot2_f32_bf16 v86, v70, v70, v86
  v_dot2_f32_bf16 v87, v71, v71, v87
  v_permlane32_swap_b32 v72, v80
  v_permlane32_swap_b32 v73, v81
  v_permlane32_swap_b32 v74, v82
  v_permlane32_swap_b32 v75, v83
  v_permlane32_swap_b32 v76, v84
  v_permlane32_swap_b32 v77, v85
  v_permlane32_swap_b32 v78, v86
  v_permlane32_swap_b32 v79, v87
  v_add_f32 v72, v72, v80
  v_add_f32 v73, v73, v81
  v_add_f32 v74, v74, v82
  v_add_f32 v75, v75, v83
  v_add_f32 v76, v76, v84
  v_add_f32 v77, v77, v85
  v_add_f32 v78, v78, v86
  v_add_f32 v79, v79, v87
  v_permlane16_swap_b32 v72, v76
  v_permlane16_swap_b32 v73, v77
  v_permlane16_swap_b32 v74, v78
  v_permlane16_swap_b32 v75, v79
  v_add_f32 v72, v72, v76
  v_add_f32 v73, v73, v77
  v_add_f32 v74, v74, v78
  v_add_f32 v75, v75, v79
  v_add_f32_dpp v72, v72, v72 row_ror:8 row_mask:0xf bank_mask:0xf
  v_add_f32_dpp v73, v73, v73 row_ror:8 row_mask:0xf bank_mask:0xf
  v_add_f32_dpp v74, v74, v74 row_ror:8 row_mask:0xf bank_mask:0xf
  v_add_f32_dpp v75, v75, v75 row_ror:8 row_mask:0xf bank_mask:0xf
  ds_write_b128 v4, v[72:75] offset:24576
  s_waitcnt lgkmcnt(0)
  s_barrier
  s_cmp_lg_u32 s28, 0
  s_cbranch_scc1 SP_done
  ds_read_b32 v8, v5 offset:24576
  ds_read_b32 v9, v5 offset:24832
  ds_read_b32 v10, v5 offset:25088
  ds_read_b32 v11, v5 offset:25344
  ds_read_b32 v12, v5 offset:25600
  ds_read_b32 v13, v5 offset:25856
  ds_read_b32 v14, v5 offset:26112
  ds_read_b32 v15, v5 offset:26368
  s_waitcnt lgkmcnt(0)
  v_pk_add_f32 v[8:9], v[8:9], v[10:11]
  v_pk_add_f32 v[12:13], v[12:13], v[14:15]
  v_pk_add_f32 v[8:9], v[8:9], v[12:13]
  v_mov_b32 v10, v9
  v_mov_b32 v11, v9
  v_mov_b32 v9, v8
  s_mov_b32 s88, 0x3b124925
  s_mov_b32 s89, 0x3727c5ac
  v_mul_f32 v8, s88, v8
  v_mul_f32 v9, s88, v9
  v_mul_f32 v10, s88, v10
  v_mul_f32 v11, s88, v11
  v_fma_f32 v10, -v8, v8, v10
  v_fma_f32 v11, -v9, v9, v11
  v_max_f32 v10, 0, v10
  v_max_f32 v11, 0, v11
  v_cvt_pk_bf16_f32 v22, v8, v9
  v_lshlrev_b32 v16, 16, v22
  v_and_b32 v17, s91, v22
  v_cvt_pk_bf16_f32 v22, v10, v11
  v_lshlrev_b32 v20, 16, v22
  v_and_b32 v21, s91, v22
  v_add_f32 v20, s89, v20
  v_add_f32 v21, s89, v21
  v_cvt_pk_bf16_f32 v22, v20, v21
  v_lshlrev_b32 v20, 16, v22
  v_and_b32 v21, s91, v22
  v_sqrt_f32 v20, v20
  v_sqrt_f32 v21, v21
  s_nop 0
  v_cvt_pk_bf16_f32 v22, v20, v21
  v_lshlrev_b32 v20, 16, v22
  v_and_b32 v21, s91, v22
  v_lshrrev_b32 v16, 16, v16
  v_or_b32 v16, v16, v20
  v_mov_b32 v17, s29
  v_lshlrev_b32 v5, 1, v5
  s_lshl_b32 s80, s34, 9
  s_add_u32 s80, s80, 15860736
  buffer_store_dwordx2 v[16:17], v5, s[8:11], s80 offen sc1
SP_done:
  s_waitcnt vmcnt(0)
K_end:
  s_endpgm
.section .rodata,"a"
.p2align 6
.amdhsa_kernel sequential_preLN__ssm_conv_s4d__dense_activation_silu__prompt_kernel
  .amdhsa_next_free_vgpr 480
  .amdhsa_next_free_sgpr 102
  .amdhsa_accum_offset 256
  .amdhsa_group_segment_fixed_size 0
  .amdhsa_kernarg_size 104
  .amdhsa_user_sgpr_count 2
  .amdhsa_user_sgpr_kernarg_segment_ptr 1
  .amdhsa_system_sgpr_workgroup_id_x 1
.end_amdhsa_kernel
```
